```python
import torch

def _softmax(x, axis=-1):
    return torch.softmax(x, dim=axis)

def _gelu(x):
    return torch.nn.functional.gelu(x, approximate='tanh')

def _silu(x):
    return torch.nn.functional.silu(x)

def _sigmoid(x):
    return torch.sigmoid(x)

def _layernorm(x, axis=-1, eps=1e-05):
    m = x.mean(dim=axis, keepdim=True)
    v = x.var(dim=axis, keepdim=True, unbiased=False)
    return (x - m) / torch.sqrt(v + eps)

def _scatter_add(tgt, idx, src, axis=0):
    return tgt.clone().index_add_(axis, idx, src)

def _segment_sum(src, seg, n):
    out = torch.zeros((n,) + src.shape[1:], dtype=src.dtype)
    return out.index_add_(0, seg, src)

def _pad(x, pw):
    flat = tuple((v for pair in reversed(pw) for v in pair))
    return torch.nn.functional.pad(x, flat)
kernel_name = 'adaLN_cond__spectral_gfnet__glu_gated_bilinear__prompt'

def setup_inputs():

    _w = lambda a: (lambda t: t.to(torch.bfloat16) if t.is_floating_point() else t)(torch.as_tensor(a))

    def _A_setup():
        B, S, D = (1, 2048, 640)
        Df = D // 2 + 1
        return {'x': _w((lambda *s: torch.randn(*s, dtype=torch.bfloat16) * 0.05)(B, S, D)), 'w_r': _w((lambda *s: torch.randn(*s, dtype=torch.bfloat16) * 1.6)(S, Df) * 0.02), 'w_i': _w((lambda *s: torch.randn(*s, dtype=torch.bfloat16) * 1.6)(S, Df) * 0.02)}
    _A_in = _A_setup()

    def _B_setup():
        B, S, D, F = (1, 2048, 640, 1536)
        return {'x': _w((lambda *s: torch.randn(*s, dtype=torch.bfloat16) * 0.05)(B, S, D)), 'w_gate': _w((lambda *s: torch.randn(*s, dtype=torch.bfloat16) * 0.4)(D, F) * D ** (-0.5)), 'w_up': _w((lambda *s: torch.randn(*s, dtype=torch.bfloat16) * 0.4)(D, F) * D ** (-0.5)), 'w_down': _w((lambda *s: torch.randn(*s, dtype=torch.bfloat16) * 0.4)(F, D) * F ** (-0.5))}
    _B_in = _B_setup()
    return {'A_x': _A_in['x'], 'A_w_r': _A_in['w_r'], 'A_w_i': _A_in['w_i'], 'B_x': _B_in['x'], 'B_w_gate': _B_in['w_gate'], 'B_w_up': _B_in['w_up'], 'B_w_down': _B_in['w_down'], 'c': _w((lambda *s: torch.randn(*s, dtype=torch.bfloat16) * 0.1)(1, 640) * 8.0), 'w_mod': _w((lambda *s: torch.randn(*s, dtype=torch.bfloat16) * 0.1)(640, 6 * 640) * 640 ** (-0.5) * 8.0)}

def reference(A_x, A_w_r, A_w_i, B_x, B_w_gate, B_w_up, B_w_down, c, w_mod):

    def _A_ref(x, w_r, w_i):
        B, S, D = x.shape
        X = (lambda x, axes=(-2, -1): torch.fft.rfft2(x.float(), dim=axes))(x, axes=(-2, -1))
        W = w_r + 1j * w_i
        X = X * W
        y = (lambda x, s, axes=(-2, -1): torch.fft.irfft2(x, s=s, dim=axes).to(torch.bfloat16))(X, (S, D), axes=(-2, -1))
        return y

    def _B_ref(x, w_gate, w_up, w_down):
        g = torch.einsum('bsd,df->bsf', x, w_gate)
        u = torch.einsum('bsd,df->bsf', x, w_up)
        h = g * u
        return torch.einsum('bsf,fd->bsd', h, w_down)
    x = A_x
    mod = (_silu(c) @ w_mod).reshape(c.shape[0], 6, 1, -1)
    sa, ca, ga, sb, cb, gb = (mod[:, 0].clone(), mod[:, 1].clone(), mod[:, 2].clone(), mod[:, 3].clone(), mod[:, 4].clone(), mod[:, 5].clone())
    h = _layernorm(x, axis=-1) * (1 + ca) + sa
    x = x + ga * _A_ref(h, A_w_r, A_w_i)
    h = _layernorm(x, axis=-1) * (1 + cb) + sb
    x = x + gb * _B_ref(h, B_w_gate, B_w_up, B_w_down)
    return x
```

```asm
; @launch kernel=kd_kernel grid=(256,1,1) block=(256,1,1) lds=163840
.amdgcn_target "amdgcn-amd-amdhsa--gfx950"
.text
.globl kd_kernel
.p2align 8
.type kd_kernel,@function
kd_kernel:
    s_cmp_ge_u32 s2, 256
    s_cbranch_scc1 LD_exit
    s_load_dwordx2 s[58:59], s[0:1], 88
    s_load_dwordx4 s[8:11], s[0:1], 56
    s_load_dwordx2 s[6:7], s[0:1], 0
    s_load_dwordx4 s[60:63], s[0:1], 8
    s_load_dwordx4 s[92:95], s[0:1], 32
    s_getpc_b64 s[28:29]
LU_pc0:
    s_lshr_b32 s30, s2, 3
    s_lshl_b32 s30, s30, 6
    v_lshlrev_b32 v250, 11, v0
    v_add_u32 v250, s30, v250
    v_min_u32 v250, Lcode_end-LU_pc0-4, v250
    v_mov_b32 v251, s29
    v_add_co_u32 v252, vcc, s28, v250
    s_nop 1
    v_addc_co_u32 v253, vcc, 0, v251, vcc
    v_cmp_gt_u32 vcc, 20, v0
    s_nop 0
    s_and_b64 exec, exec, vcc
    s_nop 1
    s_cbranch_execz LU_e0
    global_load_dword v255, v[252:253], off
LU_e0:
    s_mov_b64 exec, -1
    v_lshrrev_b32 v1, 6, v0
    v_and_b32 v4, 63, v0
    v_readfirstlane_b32 s22, v1
    v_lshlrev_b32 v5, 4, v4
    v_mov_b32 v27, 0
    v_lshrrev_b32 v247, 3, v0
    v_mul_u32_u24 v244, 7680, v247
    v_and_b32 v246, 7, v0
    v_lshl_add_u32 v244, v246, 4, v244
    v_lshlrev_b32 v245, 1, v247
    s_and_b32 s21, s2, 3
    s_lshr_b32 s20, s2, 2
    s_lshl_b32 s23, s20, 7
    s_mul_i32 s3, s21, 1228800
    s_add_u32 s23, s23, s3
    s_cmp_lt_u32 s2, 240
    s_cselect_b32 s23, s23, 0x7f000000
    s_mul_i32 s3, s21, 320
    s_waitcnt lgkmcnt(0)
    s_mov_b32 s24, s10
    s_mov_b32 s25, s11
    s_mov_b32 s26, 4915200
    s_mov_b32 s27, 0x00020000
    s_load_dword s100, s[58:59], 32768
    s_mov_b32 s28, s8
    s_mov_b32 s29, s9
    s_mov_b32 s30, 1280
    s_mov_b32 s31, 0x00020000
    buffer_load_dwordx4 v[188:191], v244, s[24:27], s23 offen nt
    s_add_u32 s23, s23, 245760
    buffer_load_ushort v234, v245, s[28:31], s3 offen offset:0
    buffer_load_ushort v235, v245, s[28:31], s3 offen offset:64
    buffer_load_ushort v236, v245, s[28:31], s3 offen offset:128
    buffer_load_ushort v237, v245, s[28:31], s3 offen offset:192
    buffer_load_ushort v238, v245, s[28:31], s3 offen offset:256
    buffer_load_dwordx4 v[192:195], v244, s[24:27], s23 offen nt
    s_add_u32 s23, s23, 245760
    buffer_load_dwordx4 v[196:199], v244, s[24:27], s23 offen nt
    s_add_u32 s23, s23, 245760
    buffer_load_dwordx4 v[200:203], v244, s[24:27], s23 offen nt
    s_add_u32 s23, s23, 245760
    buffer_load_dwordx4 v[204:207], v244, s[24:27], s23 offen nt
    s_mov_b32 s12, s58
    s_mov_b32 s13, s59
    s_mov_b32 s14, 25714688
    s_mov_b32 s15, 0x00020000
    s_mov_b32 s8, s6
    s_mov_b32 s9, s7
    s_mov_b32 s10, 2621440
    s_mov_b32 s11, 0x00020000
    v_and_b32 v7, 15, v4
    v_lshrrev_b32 v8, 4, v4
    s_and_b32 s32, s2, 6
    s_lshl_b32 s32, s32, 1
    s_lshr_b32 s33, s2, 6
    s_add_u32 s32, s32, s33
    s_bfe_u32 s33, s2, 0x30003
    s_and_b32 s3, s2, 1
    s_lshl_b32 s3, s3, 3
    s_add_u32 s33, s33, s3
    s_lshl_b32 s34, s32, 7
    s_lshl_b32 s3, s33, 1
    s_add_u32 s34, s34, s3
    s_and_b32 s3, s22, 1
    s_lshl_b32 s3, s3, 6
    s_add_u32 s34, s34, s3
    s_lshr_b32 s3, s22, 1
    s_add_u32 s34, s34, s3
    s_mul_i32 s34, s34, 1280
    s_add_u32 s35, s34, 40960
    s_mul_i32 s36, s22, 2560
    s_add_u32 s36, s36, 32768
    s_add_u32 s37, s36, 1280
    s_lshl_b32 s3, s32, 4
    s_add_u32 s3, s3, s33
    s_mul_i32 s3, s3, 10368
    s_add_u32 s3, s3, 23003136
    s_add_u32 s40, s58, s3
    s_addc_u32 s41, s59, 0
    s_mov_b32 s42, 10304
    s_mov_b32 s43, 0x00020000
    s_movk_i32 s38, 0x1000
    s_movk_i32 s39, 0x2000
    v_lshlrev_b32 v15, 4, v0
    v_mov_b32 v176, 0
    v_mov_b32 v177, 0
    v_mov_b32 v178, 0
    v_mov_b32 v179, 0
    s_sub_u32 s44, s2, 128
    s_lshr_b32 s45, s2, 7
    s_and_b32 s49, s44, 7
    s_lshl_b32 s46, s49, 2
    s_add_u32 s46, s46, s22
    s_lshl_b32 s46, s46, 3
    s_bfe_u32 s3, s44, 0x30003
    s_add_u32 s46, s46, s3
    s_mul_i32 s46, s46, 5136
    s_cmp_eq_u32 s45, 1
    s_cselect_b32 s46, s46, 0x7f000000
    s_add_u32 s47, s46, 4096
    s_bitcmp0_b32 s44, 6
    s_cselect_b32 s16, s60, s62
    s_cselect_b32 s17, s61, s63
    s_mov_b32 s18, 1314816
    s_mov_b32 s19, 0x00020000
    s_mul_i32 s48, s22, 5152
    s_add_u32 s48, s48, 81920
    s_add_u32 s7, s48, 4096
    s_lshr_b32 s6, s44, 4
    s_lshl_b32 s6, s6, 11
    s_lshl_b32 s3, s49, 8
    s_add_u32 s6, s6, s3
    s_and_b32 s3, s44, 8
    s_lshl_b32 s3, s3, 4
    s_add_u32 s6, s6, s3
    s_add_u32 s6, s6, 2752512
    s_cmp_eq_u32 s45, 1
    s_cselect_b32 s6, s6, 0x7f000000
    s_cselect_b64 s[32:33], -1, 0
    v_cvt_f32_u32 v48, v7
    v_cvt_f32_u32 v49, v8
    v_mul_f32 v50, 4.0, v49
    s_mov_b32 m0, s36
    s_nop 0
    buffer_load_dwordx4 v5, s[8:11], s34 offen lds
    s_mov_b64 exec, 0xffff
    buffer_load_dwordx4 v5, s[8:11], s34 offen offset:1024 lds
    s_mov_b64 exec, -1
    s_mov_b32 m0, s37
    s_nop 0
    buffer_load_dwordx4 v5, s[8:11], s35 offen lds
    s_mov_b64 exec, 0xffff
    buffer_load_dwordx4 v5, s[8:11], s35 offen offset:1024 lds
    s_mov_b64 exec, -1
    buffer_store_dwordx4 v[176:179], v15, s[40:43], 0 offen sc1
    buffer_store_dwordx4 v[176:179], v15, s[40:43], s38 offen sc1
    buffer_store_dwordx4 v[176:179], v15, s[40:43], s39 offen sc1
    s_mov_b64 exec, s[32:33]
    s_mov_b32 m0, s48
    s_nop 0
    buffer_load_dwordx4 v5, s[16:19], s46 offen offset:0 nt lds
    buffer_load_dwordx4 v5, s[16:19], s46 offen offset:1024 nt lds
    buffer_load_dwordx4 v5, s[16:19], s46 offen offset:2048 nt lds
    buffer_load_dwordx4 v5, s[16:19], s46 offen offset:3072 nt lds
    s_mov_b32 m0, s7
    s_nop 0
    buffer_load_dwordx4 v5, s[16:19], s47 offen nt lds
    s_and_b64 exec, exec, 1
    buffer_load_dwordx4 v5, s[16:19], s47 offen offset:1024 nt lds
    s_mov_b64 exec, -1
    v_add_u32 v12, 51200, v5
    s_cmp_eq_u32 s22, 3
    s_cbranch_scc1 LU_c3
    v_lshl_add_u32 v52, v1, 4, v7
    v_cmp_gt_u32 vcc, 40, v52
    v_cvt_f32_u32 v52, v52
    v_mul_f32 v53, 0x3ccccccd, v52
    v_mul_f32 v54, v49, v53
    v_fmamk_f32 v98, v53, 0x00000000, v54
    v_fmamk_f32 v99, v53, 0x40800000, v54
    v_fmamk_f32 v100, v53, 0x41000000, v54
    v_fmamk_f32 v101, v53, 0x41400000, v54
    v_fmamk_f32 v102, v53, 0x41800000, v54
    v_fmamk_f32 v103, v53, 0x41a00000, v54
    v_fmamk_f32 v104, v53, 0x41c00000, v54
    v_fmamk_f32 v105, v53, 0x41e00000, v54
    v_fmamk_f32 v106, v53, 0x42000000, v54
    v_fmamk_f32 v107, v53, 0x42100000, v54
    v_mul_f32 v53, 0x3acccccd, v52
    v_mul_f32 v54, v50, v53
    v_fmamk_f32 v112, v53, 0x00000000, v54
    v_fmamk_f32 v113, v53, 0x3f800000, v54
    v_fmamk_f32 v114, v53, 0x40000000, v54
    v_fmamk_f32 v115, v53, 0x40400000, v54
    v_cos_f32 v88, v98
    v_sin_f32 v98, v98
    v_cos_f32 v89, v99
    v_sin_f32 v99, v99
    v_cos_f32 v90, v100
    v_sin_f32 v100, v100
    v_cos_f32 v91, v101
    v_sin_f32 v101, v101
    v_cos_f32 v92, v102
    v_sin_f32 v102, v102
    v_cos_f32 v93, v103
    v_sin_f32 v103, v103
    v_cos_f32 v94, v104
    v_sin_f32 v104, v104
    v_cos_f32 v95, v105
    v_sin_f32 v105, v105
    v_cos_f32 v96, v106
    v_sin_f32 v106, v106
    v_cos_f32 v97, v107
    v_sin_f32 v107, v107
    v_cos_f32 v108, v112
    v_sin_f32 v112, v112
    v_cos_f32 v109, v113
    v_sin_f32 v113, v113
    v_cos_f32 v110, v114
    v_sin_f32 v114, v114
    v_cos_f32 v111, v115
    v_sin_f32 v115, v115
    v_cvt_pk_bf16_f32 v68, v88, v98
    v_cvt_pk_bf16_f32 v78, -v98, v88
    v_cvt_pk_bf16_f32 v69, v89, v99
    v_cvt_pk_bf16_f32 v79, -v99, v89
    v_cvt_pk_bf16_f32 v70, v90, v100
    v_cvt_pk_bf16_f32 v80, -v100, v90
    v_cvt_pk_bf16_f32 v71, v91, v101
    v_cvt_pk_bf16_f32 v81, -v101, v91
    v_cvt_pk_bf16_f32 v72, v92, v102
    v_cvt_pk_bf16_f32 v82, -v102, v92
    v_cvt_pk_bf16_f32 v73, v93, v103
    v_cvt_pk_bf16_f32 v83, -v103, v93
    v_cvt_pk_bf16_f32 v74, v94, v104
    v_cvt_pk_bf16_f32 v84, -v104, v94
    v_cvt_pk_bf16_f32 v75, v95, v105
    v_cvt_pk_bf16_f32 v85, -v105, v95
    v_cvt_pk_bf16_f32 v76, v96, v106
    v_cvt_pk_bf16_f32 v86, -v106, v96
    v_cvt_pk_bf16_f32 v77, v97, v107
    v_cvt_pk_bf16_f32 v87, -v107, v97
    v_cndmask_b32 v108, 0, v108, vcc
    v_cndmask_b32 v109, 0, v109, vcc
    v_cndmask_b32 v110, 0, v110, vcc
    v_cndmask_b32 v111, 0, v111, vcc
    v_cndmask_b32 v112, 0, v112, vcc
    v_cndmask_b32 v113, 0, v113, vcc
    v_cndmask_b32 v114, 0, v114, vcc
    v_cndmask_b32 v115, 0, v115, vcc
    v_lshl_add_u32 v13, v1, 10, v12
    v_lshl_add_u32 v14, v1, 12, v13
    ds_write_b128 v14, v[68:71] offset:0
    ds_write_b128 v14, v[72:75] offset:1024
    ds_write_b128 v14, v[76:79] offset:2048
    ds_write_b128 v14, v[80:83] offset:3072
    ds_write_b128 v14, v[84:87] offset:4096
    ds_write_b128 v13, v[108:111] offset:17408
    ds_write_b128 v13, v[112:115] offset:20480
    s_branch LU_c4
LU_c3:
    v_lshrrev_b32 v52, 1, v7
    v_cvt_f32_u32 v52, v52
    v_and_b32 v53, 1, v7
    v_cvt_f32_u32 v53, v53
    v_mul_f32 v53, 0x3e800000, v53
    v_add_f32 v54, 0x00000000, v52
    v_mul_f32 v54, 0x3d800000, v54
    v_fma_f32 v55, v50, v54, v53
    v_fmamk_f32 v172, v54, 0x00000000, v55
    v_fmamk_f32 v173, v54, 0x3f800000, v55
    v_fmamk_f32 v174, v54, 0x40000000, v55
    v_fmamk_f32 v175, v54, 0x40400000, v55
    v_cos_f32 v168, v172
    v_sin_f32 v172, v172
    v_cos_f32 v169, v173
    v_sin_f32 v173, v173
    v_cos_f32 v170, v174
    v_sin_f32 v174, v174
    v_cos_f32 v171, v175
    v_sin_f32 v175, v175
    v_cvt_pk_bf16_f32 v160, v168, v169
    v_cvt_pk_bf16_f32 v161, v170, v171
    v_cvt_pk_bf16_f32 v162, v172, v173
    v_cvt_pk_bf16_f32 v163, v174, v175
    v_add_f32 v54, 0x41000000, v52
    v_mul_f32 v54, 0x3d800000, v54
    v_fma_f32 v55, v50, v54, v53
    v_fmamk_f32 v172, v54, 0x00000000, v55
    v_fmamk_f32 v173, v54, 0x3f800000, v55
    v_fmamk_f32 v174, v54, 0x40000000, v55
    v_fmamk_f32 v175, v54, 0x40400000, v55
    v_cos_f32 v168, v172
    v_sin_f32 v172, v172
    v_cos_f32 v169, v173
    v_sin_f32 v173, v173
    v_cos_f32 v170, v174
    v_sin_f32 v174, v174
    v_cos_f32 v171, v175
    v_sin_f32 v175, v175
    v_cvt_pk_bf16_f32 v164, v168, v169
    v_cvt_pk_bf16_f32 v165, v170, v171
    v_cvt_pk_bf16_f32 v166, v172, v173
    v_cvt_pk_bf16_f32 v167, v174, v175
    v_mul_f32 v54, 0x3d800000, v48
    v_mul_f32 v55, v50, v54
    v_fmamk_f32 v172, v54, 0x00000000, v55
    v_fmamk_f32 v173, v54, 0x3f800000, v55
    v_fmamk_f32 v174, v54, 0x40000000, v55
    v_fmamk_f32 v175, v54, 0x40400000, v55
    v_cos_f32 v168, v172
    v_sin_f32 v172, v172
    v_cos_f32 v169, v173
    v_sin_f32 v173, v173
    v_cos_f32 v170, v174
    v_sin_f32 v174, v174
    v_cos_f32 v171, v175
    v_sin_f32 v175, v175
    v_cvt_pk_bf16_f32 v130, v172, v173
    v_cvt_pk_bf16_f32 v132, v168, v169
    v_cvt_pk_bf16_f32 v134, -v172, -v173
    v_cvt_pk_bf16_f32 v131, v174, v175
    v_cvt_pk_bf16_f32 v133, v170, v171
    v_cvt_pk_bf16_f32 v135, -v174, -v175
    v_mov_b32 v128, 0
    v_mov_b32 v129, 0
    ds_write_b128 v12, v[128:131] offset:15360
    ds_write_b128 v12, v[132:135] offset:16384
    ds_write_b128 v12, v[160:163] offset:23552
    ds_write_b128 v12, v[164:167] offset:24576
LU_c4:
    s_waitcnt vmcnt(21)
    v_lshlrev_b32 v234, 16, v234
    s_waitcnt vmcnt(20)
    v_lshlrev_b32 v235, 16, v235
    s_waitcnt vmcnt(19)
    v_lshlrev_b32 v236, 16, v236
    s_waitcnt vmcnt(18)
    v_lshlrev_b32 v237, 16, v237
    s_waitcnt vmcnt(17)
    v_lshlrev_b32 v238, 16, v238
    v_mul_f32 v239, 0xbfb8aa3b, v234
    v_mul_f32 v240, 0xbfb8aa3b, v235
    v_mul_f32 v241, 0xbfb8aa3b, v236
    v_mul_f32 v242, 0xbfb8aa3b, v237
    v_mul_f32 v243, 0xbfb8aa3b, v238
    v_exp_f32 v239, v239
    v_exp_f32 v240, v240
    v_exp_f32 v241, v241
    v_exp_f32 v242, v242
    v_exp_f32 v243, v243
    v_add_f32 v239, 1.0, v239
    v_add_f32 v240, 1.0, v240
    v_add_f32 v241, 1.0, v241
    v_add_f32 v242, 1.0, v242
    v_add_f32 v243, 1.0, v243
    v_rcp_f32 v239, v239
    v_rcp_f32 v240, v240
    v_rcp_f32 v241, v241
    v_rcp_f32 v242, v242
    v_rcp_f32 v243, v243
    v_mul_f32 v234, v234, v239
    v_mul_f32 v235, v235, v240
    v_mul_f32 v236, v236, v241
    v_mul_f32 v237, v237, v242
    v_mul_f32 v238, v238, v243
    v_cvt_pk_bf16_f32 v234, v234, v234
    v_cvt_pk_bf16_f32 v235, v235, v235
    v_cvt_pk_bf16_f32 v236, v236, v236
    v_cvt_pk_bf16_f32 v237, v237, v237
    v_cvt_pk_bf16_f32 v238, v238, v238
    v_and_b32 v224, 0xffff0000, v234
    v_and_b32 v226, 0xffff0000, v235
    v_and_b32 v228, 0xffff0000, v236
    v_and_b32 v230, 0xffff0000, v237
    v_and_b32 v232, 0xffff0000, v238
    v_lshlrev_b32 v216, 16, v188
    v_and_b32 v217, 0xffff0000, v188
    v_lshlrev_b32 v218, 16, v189
    v_and_b32 v219, 0xffff0000, v189
    v_lshlrev_b32 v220, 16, v190
    v_and_b32 v221, 0xffff0000, v190
    v_lshlrev_b32 v222, 16, v191
    v_and_b32 v223, 0xffff0000, v191
    v_pk_mul_f32 v[208:209], v[216:217], v[224:225] op_sel_hi:[1,0]
    v_pk_mul_f32 v[210:211], v[218:219], v[224:225] op_sel_hi:[1,0]
    v_pk_mul_f32 v[212:213], v[220:221], v[224:225] op_sel_hi:[1,0]
    v_pk_mul_f32 v[214:215], v[222:223], v[224:225] op_sel_hi:[1,0]
    s_waitcnt vmcnt(16)
    v_lshlrev_b32 v216, 16, v192
    v_and_b32 v217, 0xffff0000, v192
    v_lshlrev_b32 v218, 16, v193
    v_and_b32 v219, 0xffff0000, v193
    v_lshlrev_b32 v220, 16, v194
    v_and_b32 v221, 0xffff0000, v194
    v_lshlrev_b32 v222, 16, v195
    v_and_b32 v223, 0xffff0000, v195
    v_pk_fma_f32 v[208:209], v[216:217], v[226:227], v[208:209] op_sel_hi:[1,0,1]
    v_pk_fma_f32 v[210:211], v[218:219], v[226:227], v[210:211] op_sel_hi:[1,0,1]
    v_pk_fma_f32 v[212:213], v[220:221], v[226:227], v[212:213] op_sel_hi:[1,0,1]
    v_pk_fma_f32 v[214:215], v[222:223], v[226:227], v[214:215] op_sel_hi:[1,0,1]
    s_waitcnt vmcnt(15)
    v_lshlrev_b32 v216, 16, v196
    v_and_b32 v217, 0xffff0000, v196
    v_lshlrev_b32 v218, 16, v197
    v_and_b32 v219, 0xffff0000, v197
    v_lshlrev_b32 v220, 16, v198
    v_and_b32 v221, 0xffff0000, v198
    v_lshlrev_b32 v222, 16, v199
    v_and_b32 v223, 0xffff0000, v199
    v_pk_fma_f32 v[208:209], v[216:217], v[228:229], v[208:209] op_sel_hi:[1,0,1]
    v_pk_fma_f32 v[210:211], v[218:219], v[228:229], v[210:211] op_sel_hi:[1,0,1]
    v_pk_fma_f32 v[212:213], v[220:221], v[228:229], v[212:213] op_sel_hi:[1,0,1]
    v_pk_fma_f32 v[214:215], v[222:223], v[228:229], v[214:215] op_sel_hi:[1,0,1]
    s_waitcnt vmcnt(14)
    v_lshlrev_b32 v216, 16, v200
    v_and_b32 v217, 0xffff0000, v200
    v_lshlrev_b32 v218, 16, v201
    v_and_b32 v219, 0xffff0000, v201
    v_lshlrev_b32 v220, 16, v202
    v_and_b32 v221, 0xffff0000, v202
    v_lshlrev_b32 v222, 16, v203
    v_and_b32 v223, 0xffff0000, v203
    v_pk_fma_f32 v[208:209], v[216:217], v[230:231], v[208:209] op_sel_hi:[1,0,1]
    v_pk_fma_f32 v[210:211], v[218:219], v[230:231], v[210:211] op_sel_hi:[1,0,1]
    v_pk_fma_f32 v[212:213], v[220:221], v[230:231], v[212:213] op_sel_hi:[1,0,1]
    v_pk_fma_f32 v[214:215], v[222:223], v[230:231], v[214:215] op_sel_hi:[1,0,1]
    s_waitcnt vmcnt(13)
    v_lshlrev_b32 v216, 16, v204
    v_and_b32 v217, 0xffff0000, v204
    v_lshlrev_b32 v218, 16, v205
    v_and_b32 v219, 0xffff0000, v205
    v_lshlrev_b32 v220, 16, v206
    v_and_b32 v221, 0xffff0000, v206
    v_lshlrev_b32 v222, 16, v207
    v_and_b32 v223, 0xffff0000, v207
    v_pk_fma_f32 v[208:209], v[216:217], v[232:233], v[208:209] op_sel_hi:[1,0,1]
    v_pk_fma_f32 v[210:211], v[218:219], v[232:233], v[210:211] op_sel_hi:[1,0,1]
    v_pk_fma_f32 v[212:213], v[220:221], v[232:233], v[212:213] op_sel_hi:[1,0,1]
    v_pk_fma_f32 v[214:215], v[222:223], v[232:233], v[214:215] op_sel_hi:[1,0,1]
    v_add_f32_dpp v208, v208, v208 row_ror:8 row_mask:0xf bank_mask:0xf
    v_add_f32_dpp v209, v209, v209 row_ror:8 row_mask:0xf bank_mask:0xf
    v_add_f32_dpp v210, v210, v210 row_ror:8 row_mask:0xf bank_mask:0xf
    v_add_f32_dpp v211, v211, v211 row_ror:8 row_mask:0xf bank_mask:0xf
    v_add_f32_dpp v212, v212, v212 row_ror:8 row_mask:0xf bank_mask:0xf
    v_add_f32_dpp v213, v213, v213 row_ror:8 row_mask:0xf bank_mask:0xf
    v_add_f32_dpp v214, v214, v214 row_ror:8 row_mask:0xf bank_mask:0xf
    v_add_f32_dpp v215, v215, v215 row_ror:8 row_mask:0xf bank_mask:0xf
    v_lshrrev_b32 v247, 4, v0
    v_lshlrev_b32 v247, 8, v247
    v_lshl_add_u32 v247, v246, 5, v247
    s_mov_b32 exec_lo, 0x00ff00ff
    s_mov_b32 exec_hi, 0x00ff00ff
    ds_write_b128 v247, v[208:211] offset:26112
    ds_write_b128 v247, v[212:215] offset:26128
    s_mov_b64 exec, -1
    v_lshlrev_b32 v246, 2, v4
    v_add_u32 v247, 26112, v246
    s_waitcnt vmcnt(6)
    s_waitcnt lgkmcnt(0)
    s_barrier
    s_add_u32 s100, s100, 1
    v_mov_b32 v248, s100
    s_lshl_b32 s3, s2, 2
    s_add_u32 s3, s3, 49152
    s_cmp_eq_u32 s22, 3
    s_cselect_b64 exec, 1, 0
    buffer_store_dword v248, v27, s[12:15], s3 offen sc1
    s_mov_b64 exec, -1
    s_cmp_lg_u32 s22, 0
    s_cbranch_scc1 LU_m1
    ds_read2st64_b32 v[188:189], v247 offset0:0 offset1:1
    ds_read2st64_b32 v[190:191], v247 offset0:2 offset1:3
    ds_read2st64_b32 v[192:193], v247 offset0:4 offset1:5
    ds_read2st64_b32 v[194:195], v247 offset0:6 offset1:7
    ds_read2st64_b32 v[196:197], v247 offset0:8 offset1:9
    ds_read2st64_b32 v[198:199], v247 offset0:10 offset1:11
    ds_read2st64_b32 v[200:201], v247 offset0:12 offset1:13
    ds_read2st64_b32 v[202:203], v247 offset0:14 offset1:15
    s_sub_u32 s3, s20, 10
    s_cmp_lt_u32 s3, 10
    s_cselect_b32 s23, 1.0, 0
    s_cmp_eq_u32 s21, 0
    s_cselect_b32 s23, s23, 0
    s_mul_i32 s50, s21, 15360
    s_lshl_b32 s3, s20, 8
    s_add_u32 s50, s50, s3
    s_add_u32 s50, s50, 22937600
    s_cmp_lt_u32 s2, 240
    s_cselect_b32 s50, s50, 0x7f000000
    s_mov_b32 s4, 0x07060503
    s_mov_b32 s5, 0x07060502
    s_mov_b32 s51, 0x07060501
    s_waitcnt lgkmcnt(3)
    v_pk_add_f32 v[188:189], v[188:189], v[196:197]
    s_waitcnt lgkmcnt(2)
    v_pk_add_f32 v[190:191], v[190:191], v[198:199]
    s_waitcnt lgkmcnt(1)
    v_pk_add_f32 v[192:193], v[192:193], v[200:201]
    s_waitcnt lgkmcnt(0)
    v_pk_add_f32 v[194:195], v[194:195], v[202:203]
    v_pk_add_f32 v[188:189], v[188:189], v[192:193]
    v_pk_add_f32 v[190:191], v[190:191], v[194:195]
    v_pk_add_f32 v[188:189], v[188:189], v[190:191]
    v_add_f32 v188, v188, v189
    v_add_f32 v188, s23, v188
    s_nop 1
    v_mov_b32_dpp v189, v188 quad_perm:[1,1,1,1] row_mask:0xf bank_mask:0xf
    v_mov_b32_dpp v190, v188 quad_perm:[2,2,2,2] row_mask:0xf bank_mask:0xf
    v_mov_b32_dpp v191, v188 quad_perm:[3,3,3,3] row_mask:0xf bank_mask:0xf
    v_perm_b32 v188, v188, v191, s4
    v_perm_b32 v189, v189, v191, s5
    v_perm_b32 v190, v190, v191, s51
    v_mov_b32 v191, s100
    s_mov_b32 exec_lo, 0x11111111
    s_mov_b32 exec_hi, 0x11111111
    buffer_store_dwordx4 v[188:191], v246, s[12:15], s50 offen sc1
    s_mov_b64 exec, -1
LU_m1:
    s_lshl_b32 s49, s2, 14
    s_lshl_b32 s3, s22, 12
    s_add_u32 s49, s49, s3
    s_add_u32 s49, s49, 65536
    s_cmp_lt_u32 s2, 161
    s_cselect_b32 s49, s49, 0x7f000000
    s_cselect_b64 s[90:91], -1, 0
    s_sub_u32 s89, s2, 84
    s_cmp_ge_u32 s89, 4
    s_cbranch_scc1 LU_r0
    v_lshlrev_b32 v56, 7, v0
    v_min_u32 v56, 11136, v56
    s_mov_b32 s3, 36864
    buffer_store_dword v176, v56, s[12:15], s3 offen sc1
    v_mov_b32 v168, -1
    v_mov_b32 v169, -1
    v_mov_b32 v170, -1
    v_mov_b32 v171, -1
    s_mul_i32 s3, s89, 2560
    s_add_u32 s3, s3, 5120
    v_min_u32 v56, 2544, v15
    buffer_store_dwordx4 v[168:171], v56, s[12:15], s3 offen sc1
    s_nop 0
LU_r0:
    v_add_u32 v20, 0, v4
    v_mul_u32_u24 v20, 171, v20
    v_lshrrev_b32 v20, 12, v20
    v_mul_u32_u24 v20, 2688, v20
    v_add_u32 v20, v20, v5
    v_add_u32 v21, 64, v4
    v_mul_u32_u24 v21, 171, v21
    v_lshrrev_b32 v21, 12, v21
    v_mul_u32_u24 v21, 2688, v21
    v_add_u32 v21, v21, v5
    v_add_u32 v22, 128, v4
    v_mul_u32_u24 v22, 171, v22
    v_lshrrev_b32 v22, 12, v22
    v_mul_u32_u24 v22, 2688, v22
    v_add_u32 v22, v22, v5
    s_mov_b32 s24, s92
    s_mov_b32 s25, s93
    s_mov_b32 s26, 1966080
    s_mov_b32 s27, 0x00020000
    s_mov_b32 s28, s94
    s_mov_b32 s29, s95
    s_mov_b32 s30, 1966080
    s_mov_b32 s31, 0x00020000
    s_lshr_b32 s50, s2, 3
    s_lshl_b32 s50, s50, 2
    s_add_u32 s50, s50, s22
    s_mul_i32 s50, s50, 24576
    s_and_b32 s3, s2, 7
    s_mul_i32 s3, s3, 384
    s_add_u32 s50, s50, s3
    s_not_b64 s[62:63], s[32:33]
    s_mul_i32 s20, s22, 3072
    s_add_u32 s20, s20, 102656
    s_add_u32 s21, s20, 12288
    v_mov_b32 v28, 0
    v_mov_b32 v29, 0
    v_mov_b32 v30, 0
    v_mov_b32 v31, 0
    s_mov_b64 exec, s[62:63]
    s_mov_b32 m0, s20
    s_nop 0
    buffer_load_dwordx4 v20, s[24:27], s50 offen offset:0 nt lds
    s_mov_b64 exec, -1
    v_mov_b32 v32, 0
    v_mov_b32 v33, 0
    v_mov_b32 v34, 0
    v_mov_b32 v35, 0
    s_mov_b64 exec, s[62:63]
    buffer_load_dwordx4 v21, s[24:27], s50 offen offset:1024 nt lds
    s_mov_b64 exec, -1
    v_mov_b32 v36, 0
    v_mov_b32 v37, 0
    v_mov_b32 v38, 0
    v_mov_b32 v39, 0
    s_mov_b64 exec, s[62:63]
    buffer_load_dwordx4 v22, s[24:27], s50 offen offset:2048 nt lds
    s_mov_b64 exec, -1
    v_mov_b32 v40, 0
    v_mov_b32 v41, 0
    v_mov_b32 v42, 0
    v_mov_b32 v43, 0
    s_mov_b64 exec, s[62:63]
    s_mov_b32 m0, s21
    s_nop 0
    buffer_load_dwordx4 v20, s[28:31], s50 offen offset:0 nt lds
    s_mov_b64 exec, -1
    v_mov_b32 v44, 0
    v_mov_b32 v45, 0
    v_mov_b32 v46, 0
    v_mov_b32 v47, 0
    s_mov_b64 exec, s[62:63]
    buffer_load_dwordx4 v21, s[28:31], s50 offen offset:1024 nt lds
    s_mov_b64 exec, -1
    v_lshl_add_u32 v52, v4, 1, s36
    ds_read_u16_d16_hi v28, v52 offset:0
    ds_read_u16_d16_hi v29, v52 offset:1280
    ds_read_u16_d16_hi v30, v52 offset:128
    s_mov_b64 exec, s[62:63]
    buffer_load_dwordx4 v22, s[28:31], s50 offen offset:2048 nt lds
    s_mov_b64 exec, -1
    ds_read_u16_d16_hi v31, v52 offset:1408
    ds_read_u16_d16_hi v32, v52 offset:256
    ds_read_u16_d16_hi v33, v52 offset:1536
    ds_read_u16_d16_hi v34, v52 offset:384
    ds_read_u16_d16_hi v35, v52 offset:1664
    ds_read_u16_d16_hi v36, v52 offset:512
    ds_read_u16_d16_hi v37, v52 offset:1792
    ds_read_u16_d16_hi v38, v52 offset:640
    ds_read_u16_d16_hi v39, v52 offset:1920
    ds_read_u16_d16_hi v40, v52 offset:768
    ds_read_u16_d16_hi v41, v52 offset:2048
    ds_read_u16_d16_hi v42, v52 offset:896
    ds_read_u16_d16_hi v43, v52 offset:2176
    ds_read_u16_d16_hi v44, v52 offset:1024
    ds_read_u16_d16_hi v45, v52 offset:2304
    ds_read_u16_d16_hi v46, v52 offset:1152
    ds_read_u16_d16_hi v47, v52 offset:2432
    ds_read_b128 v[68:71], v12 offset:0
    ds_read_b128 v[72:75], v12 offset:1024
    ds_read_b128 v[76:79], v12 offset:2048
    ds_read_b128 v[80:83], v12 offset:3072
    ds_read_b128 v[84:87], v12 offset:4096
    ds_read_b128 v[88:91], v12 offset:5120
    ds_read_b128 v[92:95], v12 offset:6144
    ds_read_b128 v[96:99], v12 offset:7168
    ds_read_b128 v[100:103], v12 offset:8192
    ds_read_b128 v[104:107], v12 offset:9216
    ds_read_b128 v[108:111], v12 offset:10240
    ds_read_b128 v[112:115], v12 offset:11264
    ds_read_b128 v[116:119], v12 offset:12288
    ds_read_b128 v[120:123], v12 offset:13312
    ds_read_b128 v[124:127], v12 offset:14336
    ds_read_b128 v[128:131], v12 offset:15360
    ds_read_b128 v[136:139], v12 offset:17408
    ds_read_b128 v[140:143], v12 offset:18432
    ds_read_b128 v[144:147], v12 offset:19456
    ds_read_b128 v[148:151], v12 offset:20480
    ds_read_b128 v[152:155], v12 offset:21504
    ds_read_b128 v[156:159], v12 offset:22528
    ds_read_b128 v[160:163], v12 offset:23552
    ds_read_b128 v[164:167], v12 offset:24576
    v_mul_u32_u24 v13, 80, v8
    v_add_lshl_u32 v12, v13, v7, 3
    s_mul_i32 s3, s22, 5184
    v_add_u32 v12, s3, v12
    v_and_b32 v53, 1, v0
    v_lshrrev_b32 v54, 1, v0
    v_mul_u32_u24 v13, 10368, v53
    v_sub_u32 v14, 384, v54
    v_lshl_add_u32 v14, v14, 3, v13
    v_lshl_add_u32 v13, v54, 3, v13
    s_mul_i32 s3, s22, 1280
    v_lshl_add_u32 v16, v4, 4, s3
    s_add_u32 s3, s3, 1024
    v_lshl_add_u32 v18, v7, 4, s3
    v_mul_u32_u24 v17, 15360, v8
    v_add_u32 v17, v17, v18
    v_lshlrev_b32 v19, 2, v4
    v_add_u32 v19, 20736, v19
    v_mov_b32 v186, 0
    v_mov_b32 v187, 0
    s_waitcnt lgkmcnt(15)
    v_pk_add_f32 v[188:189], v[28:29], v[30:31]
    v_pk_mul_f32 v[190:191], v[28:29], v[28:29]
    v_pk_fma_f32 v[190:191], v[30:31], v[30:31], v[190:191]
    v_pk_add_f32 v[188:189], v[188:189], v[32:33]
    v_pk_fma_f32 v[190:191], v[32:33], v[32:33], v[190:191]
    v_pk_add_f32 v[188:189], v[188:189], v[34:35]
    v_pk_fma_f32 v[190:191], v[34:35], v[34:35], v[190:191]
    v_pk_add_f32 v[188:189], v[188:189], v[36:37]
    v_pk_fma_f32 v[190:191], v[36:37], v[36:37], v[190:191]
    v_pk_add_f32 v[188:189], v[188:189], v[38:39]
    v_pk_fma_f32 v[190:191], v[38:39], v[38:39], v[190:191]
    v_pk_add_f32 v[188:189], v[188:189], v[40:41]
    v_pk_fma_f32 v[190:191], v[40:41], v[40:41], v[190:191]
    v_pk_add_f32 v[188:189], v[188:189], v[42:43]
    v_pk_fma_f32 v[190:191], v[42:43], v[42:43], v[190:191]
    v_pk_add_f32 v[188:189], v[188:189], v[44:45]
    v_pk_fma_f32 v[190:191], v[44:45], v[44:45], v[190:191]
    v_pk_add_f32 v[188:189], v[188:189], v[46:47]
    v_pk_fma_f32 v[190:191], v[46:47], v[46:47], v[190:191]
    s_mov_b32 s52, 22937600
    s_mov_b32 s53, 22952960
    s_mov_b32 s54, 22968320
    s_mov_b32 s55, 22983680
    s_mov_b32 s60, 0x04000c0c
    s_mov_b32 s61, 0x0706000c
    v_add_f32_dpp v188, v188, v188 quad_perm:[1,0,3,2] row_mask:0xf bank_mask:0xf
    v_add_f32_dpp v189, v189, v189 quad_perm:[1,0,3,2] row_mask:0xf bank_mask:0xf
    v_add_f32_dpp v190, v190, v190 quad_perm:[1,0,3,2] row_mask:0xf bank_mask:0xf
    v_add_f32_dpp v191, v191, v191 quad_perm:[1,0,3,2] row_mask:0xf bank_mask:0xf
    v_add_f32_dpp v188, v188, v188 quad_perm:[2,3,0,1] row_mask:0xf bank_mask:0xf
    v_add_f32_dpp v189, v189, v189 quad_perm:[2,3,0,1] row_mask:0xf bank_mask:0xf
    v_add_f32_dpp v190, v190, v190 quad_perm:[2,3,0,1] row_mask:0xf bank_mask:0xf
    v_add_f32_dpp v191, v191, v191 quad_perm:[2,3,0,1] row_mask:0xf bank_mask:0xf
    v_add_f32_dpp v188, v188, v188 row_half_mirror row_mask:0xf bank_mask:0xf
    v_add_f32_dpp v189, v189, v189 row_half_mirror row_mask:0xf bank_mask:0xf
    v_add_f32_dpp v190, v190, v190 row_half_mirror row_mask:0xf bank_mask:0xf
    v_add_f32_dpp v191, v191, v191 row_half_mirror row_mask:0xf bank_mask:0xf
    v_add_f32_dpp v188, v188, v188 row_mirror row_mask:0xf bank_mask:0xf
    v_add_f32_dpp v189, v189, v189 row_mirror row_mask:0xf bank_mask:0xf
    v_add_f32_dpp v190, v190, v190 row_mirror row_mask:0xf bank_mask:0xf
    v_add_f32_dpp v191, v191, v191 row_mirror row_mask:0xf bank_mask:0xf
    v_add_f32_dpp v188, v188, v188 row_bcast:15 row_mask:0xa bank_mask:0xf
    v_add_f32_dpp v189, v189, v189 row_bcast:15 row_mask:0xa bank_mask:0xf
    v_add_f32_dpp v190, v190, v190 row_bcast:15 row_mask:0xa bank_mask:0xf
    v_add_f32_dpp v191, v191, v191 row_bcast:15 row_mask:0xa bank_mask:0xf
    v_add_f32_dpp v188, v188, v188 row_bcast:31 row_mask:0xc bank_mask:0xf
    v_add_f32_dpp v189, v189, v189 row_bcast:31 row_mask:0xc bank_mask:0xf
    v_add_f32_dpp v190, v190, v190 row_bcast:31 row_mask:0xc bank_mask:0xf
    v_add_f32_dpp v191, v191, v191 row_bcast:31 row_mask:0xc bank_mask:0xf
    v_readlane_b32 s8, v188, 63
    v_readlane_b32 s9, v189, 63
    v_readlane_b32 s10, v190, 63
    v_readlane_b32 s11, v191, 63
    v_mov_b32 v168, 0x3acccccd
    v_pk_mul_f32 v[170:171], s[8:9], v[168:169] op_sel_hi:[1,0]
    v_pk_mul_f32 v[192:193], s[10:11], v[168:169] op_sel_hi:[1,0]
    v_pk_fma_f32 v[192:193], v[170:171], v[170:171], v[192:193] neg_lo:[1,0,0] neg_hi:[1,0,0]
    v_max_f32 v192, 0, v192
    v_max_f32 v193, 0, v193
    v_add_f32 v192, 0x3727c5ac, v192
    v_add_f32 v193, 0x3727c5ac, v193
    v_rsq_f32 v192, v192
    v_rsq_f32 v193, v193
    s_nop 0
    v_pk_mul_f32 v[194:195], v[170:171], v[192:193] neg_lo:[1,0] neg_hi:[1,0]
    v_pk_fma_f32 v[28:29], v[28:29], v[192:193], v[194:195]
    v_pk_fma_f32 v[30:31], v[30:31], v[192:193], v[194:195]
    v_pk_fma_f32 v[32:33], v[32:33], v[192:193], v[194:195]
    v_pk_fma_f32 v[34:35], v[34:35], v[192:193], v[194:195]
    v_pk_fma_f32 v[36:37], v[36:37], v[192:193], v[194:195]
    v_pk_fma_f32 v[38:39], v[38:39], v[192:193], v[194:195]
    v_pk_fma_f32 v[40:41], v[40:41], v[192:193], v[194:195]
    v_pk_fma_f32 v[42:43], v[42:43], v[192:193], v[194:195]
    v_pk_fma_f32 v[44:45], v[44:45], v[192:193], v[194:195]
    v_pk_fma_f32 v[46:47], v[46:47], v[192:193], v[194:195]
    buffer_load_dwordx4 v[48:51], v16, s[12:15], s52 offen sc1
    buffer_load_dwordx4 v[52:55], v16, s[12:15], s53 offen sc1
    buffer_load_dwordx4 v[56:59], v16, s[12:15], s54 offen sc1
    buffer_load_dwordx4 v[60:63], v16, s[12:15], s55 offen sc1
    buffer_load_dwordx4 v[64:67], v17, s[12:15], s52 offen sc1
    s_waitcnt vmcnt(12)
    s_waitcnt vmcnt(5)
    s_waitcnt lgkmcnt(0)
    s_barrier
    s_cmp_eq_u32 s45, 1
    s_cbranch_scc1 LU_g1
    v_bfe_u32 v24, v4, 2, 2
    v_lshl_add_u32 v23, v8, 3, v24
    v_mul_u32_u24 v23, 384, v23
    s_mul_i32 s3, s22, 48
    s_add_u32 s3, s3, 102656
    v_add_u32 v23, s3, v23
    v_and_b32 v20, 1, v4
    v_lshl_add_u32 v24, v20, 3, v23
    v_bfe_u32 v20, v4, 1, 1
    v_mul_u32_u24 v20, 12288, v20
    v_add_u32 v24, v24, v20
    v_and_b32 v20, 3, v4
    v_lshl_add_u32 v23, v20, 3, v23
    ds_read_b64_tr_b16 v[188:189], v23 offset:0
    ds_read_b64_tr_b16 v[190:191], v23 offset:1536
    ds_read_b64_tr_b16 v[192:193], v23 offset:12288
    ds_read_b64_tr_b16 v[194:195], v23 offset:13824
    ds_read_b64_tr_b16 v[196:197], v24 offset:32
    ds_read_b64_tr_b16 v[198:199], v24 offset:1568
    ds_read_b64_tr_b16 v[200:201], v23 offset:192
    ds_read_b64_tr_b16 v[202:203], v23 offset:1728
    ds_read_b64_tr_b16 v[204:205], v23 offset:12480
    ds_read_b64_tr_b16 v[206:207], v23 offset:14016
    ds_read_b64_tr_b16 v[208:209], v24 offset:224
    ds_read_b64_tr_b16 v[210:211], v24 offset:1760
LU_g1:
    s_and_b32 s47, s2, 7
    s_lshl_b32 s47, s47, 3
    s_add_u32 s47, s47, s22
    s_mul_i32 s47, s47, 10
    s_lshr_b32 s46, s2, 3
    s_add_u32 s47, s47, s46
    s_mul_i32 s47, s47, 3072
    s_cmp_ge_u32 s46, 10
    s_cselect_b32 s3, 1935360, 0
    s_add_u32 s47, s47, s3
    s_add_u32 s47, s47, 19005440
    s_add_u32 s48, s47, 122880
    v_and_b32 v25, 7, v0
    v_lshlrev_b32 v26, 4, v25
    v_mul_u32_u24 v25, 642, v25
    v_lshrrev_b32 v20, 3, v0
    v_mul_u32_u24 v20, 5, v20
    v_lshl_add_u32 v25, v20, 2, v25
    v_add_u32 v25, 81920, v25
    v_lshl_add_u32 v26, v20, 14, v26
    s_cmp_lg_u32 s45, 1
    s_cbranch_scc1 LU_t1
    ds_read_u16 v212, v25 offset:0
    ds_read_u16 v238, v25 offset:5152
    ds_read_u16 v213, v25 offset:10304
    ds_read_u16 v239, v25 offset:15456
    ds_read_u16 v214, v25 offset:2
    ds_read_u16 v240, v25 offset:5154
    ds_read_u16 v215, v25 offset:10306
    ds_read_u16 v241, v25 offset:15458
    ds_read_u16 v216, v25 offset:4
    ds_read_u16 v242, v25 offset:5156
    ds_read_u16 v217, v25 offset:10308
    ds_read_u16 v243, v25 offset:15460
    ds_read_u16 v218, v25 offset:6
    ds_read_u16 v244, v25 offset:5158
    ds_read_u16 v219, v25 offset:10310
    ds_read_u16 v245, v25 offset:15462
    s_waitcnt lgkmcnt(14)
    v_lshl_or_b32 v212, v238, 16, v212
    s_waitcnt lgkmcnt(12)
    v_lshl_or_b32 v213, v239, 16, v213
    s_waitcnt lgkmcnt(10)
    v_lshl_or_b32 v214, v240, 16, v214
    s_waitcnt lgkmcnt(8)
    v_lshl_or_b32 v215, v241, 16, v215
    ds_read_u16 v220, v25 offset:8
    ds_read_u16 v238, v25 offset:5160
    ds_read_u16 v221, v25 offset:10312
    ds_read_u16 v239, v25 offset:15464
    ds_read_u16 v222, v25 offset:10
    ds_read_u16 v240, v25 offset:5162
    ds_read_u16 v223, v25 offset:10314
    ds_read_u16 v241, v25 offset:15466
    s_waitcnt lgkmcnt(14)
    v_lshl_or_b32 v216, v242, 16, v216
    s_waitcnt lgkmcnt(12)
    v_lshl_or_b32 v217, v243, 16, v217
    s_waitcnt lgkmcnt(10)
    v_lshl_or_b32 v218, v244, 16, v218
    s_waitcnt lgkmcnt(8)
    v_lshl_or_b32 v219, v245, 16, v219
    ds_read_u16 v224, v25 offset:12
    ds_read_u16 v242, v25 offset:5164
    ds_read_u16 v225, v25 offset:10316
    ds_read_u16 v243, v25 offset:15468
    ds_read_u16 v226, v25 offset:14
    ds_read_u16 v244, v25 offset:5166
    ds_read_u16 v227, v25 offset:10318
    ds_read_u16 v245, v25 offset:15470
    s_waitcnt lgkmcnt(14)
    v_lshl_or_b32 v220, v238, 16, v220
    s_waitcnt lgkmcnt(12)
    v_lshl_or_b32 v221, v239, 16, v221
    s_waitcnt lgkmcnt(10)
    v_lshl_or_b32 v222, v240, 16, v222
    s_waitcnt lgkmcnt(8)
    v_lshl_or_b32 v223, v241, 16, v223
    ds_read_u16 v228, v25 offset:16
    ds_read_u16 v238, v25 offset:5168
    ds_read_u16 v229, v25 offset:10320
    ds_read_u16 v239, v25 offset:15472
    ds_read_u16 v230, v25 offset:18
    ds_read_u16 v240, v25 offset:5170
    ds_read_u16 v231, v25 offset:10322
    ds_read_u16 v241, v25 offset:15474
    s_waitcnt lgkmcnt(14)
    v_lshl_or_b32 v224, v242, 16, v224
    s_waitcnt lgkmcnt(12)
    v_lshl_or_b32 v225, v243, 16, v225
    s_waitcnt lgkmcnt(10)
    v_lshl_or_b32 v226, v244, 16, v226
    s_waitcnt lgkmcnt(8)
    v_lshl_or_b32 v227, v245, 16, v227
    ds_read_u16 v232, v25 offset:640
    ds_read_u16 v242, v25 offset:5792
    ds_read_u16 v233, v25 offset:10944
    ds_read_u16 v243, v25 offset:16096
    ds_read_u16 v234, v25 offset:642
    ds_read_u16 v244, v25 offset:5794
    ds_read_u16 v235, v25 offset:10946
    ds_read_u16 v245, v25 offset:16098
    s_waitcnt lgkmcnt(14)
    v_lshl_or_b32 v228, v238, 16, v228
    s_waitcnt lgkmcnt(12)
    v_lshl_or_b32 v229, v239, 16, v229
    s_waitcnt lgkmcnt(10)
    v_lshl_or_b32 v230, v240, 16, v230
    s_waitcnt lgkmcnt(8)
    v_lshl_or_b32 v231, v241, 16, v231
    s_waitcnt lgkmcnt(6)
    v_lshl_or_b32 v232, v242, 16, v232
    s_waitcnt lgkmcnt(4)
    v_lshl_or_b32 v233, v243, 16, v233
    s_waitcnt lgkmcnt(2)
    v_lshl_or_b32 v234, v244, 16, v234
    s_waitcnt lgkmcnt(0)
    v_lshl_or_b32 v235, v245, 16, v235
    s_nop 0
LU_t1:
    v_cmp_gt_u32 s[28:29], 8, v0
    v_mov_b32 v246, 0
    v_mov_b32 v247, 0
    v_mov_b32 v248, 0
    v_mov_b32 v249, 0
    s_mov_b32 s3, 0x40000
    s_waitcnt vmcnt(4)
    v_xor_b32 v168, s100, v51
    s_waitcnt vmcnt(3)
    v_xor_b32 v169, s100, v55
    s_waitcnt vmcnt(2)
    v_xor_b32 v170, s100, v59
    s_waitcnt vmcnt(1)
    v_xor_b32 v171, s100, v63
    s_waitcnt vmcnt(0)
    v_xor_b32 v172, s100, v67
    s_nop 0
LU_poll:
    v_or3_b32 v168, v168, v169, v170
    v_or3_b32 v168, v168, v171, v172
    v_cmp_ne_u32 vcc, 0, v168
    v_perm_b32 v173, v64, v65, s60
    v_perm_b32 v67, v173, v66, s61
    v_perm_b32 v169, v48, v49, s60
    v_perm_b32 v51, v169, v50, s61
    v_perm_b32 v170, v52, v53, s60
    v_perm_b32 v55, v170, v54, s61
    v_perm_b32 v171, v56, v57, s60
    v_perm_b32 v59, v171, v58, s61
    v_perm_b32 v172, v60, v61, s60
    v_perm_b32 v63, v172, v62, s61
    s_nop 0
    s_cbranch_vccz LU_go
    s_sub_u32 s3, s3, 1
    s_cbranch_scc1 LU_go
    s_sleep 2
    buffer_load_dwordx4 v[48:51], v16, s[12:15], s52 offen sc1
    buffer_load_dwordx4 v[52:55], v16, s[12:15], s53 offen sc1
    buffer_load_dwordx4 v[56:59], v16, s[12:15], s54 offen sc1
    buffer_load_dwordx4 v[60:63], v16, s[12:15], s55 offen sc1
    buffer_load_dwordx4 v[64:67], v17, s[12:15], s52 offen sc1
    s_waitcnt vmcnt(4)
    v_xor_b32 v168, s100, v51
    s_waitcnt vmcnt(3)
    v_xor_b32 v169, s100, v55
    s_waitcnt vmcnt(2)
    v_xor_b32 v170, s100, v59
    s_waitcnt vmcnt(1)
    v_xor_b32 v171, s100, v63
    s_waitcnt vmcnt(0)
    v_xor_b32 v172, s100, v67
    s_nop 0
    s_branch LU_poll
LU_go:
    v_mov_b32 v168, v64
    v_mov_b32 v169, v65
    v_mov_b32 v170, v66
    v_mov_b32 v171, v67
    v_pk_add_f32 v[48:49], v[48:49], v[52:53]
    v_pk_add_f32 v[56:57], v[56:57], v[60:61]
    v_pk_add_f32 v[50:51], v[50:51], v[54:55]
    v_pk_add_f32 v[58:59], v[58:59], v[62:63]
    v_permlane32_swap_b32 v168, v64
    v_permlane32_swap_b32 v169, v65
    v_permlane32_swap_b32 v170, v66
    v_permlane32_swap_b32 v171, v67
    s_mov_b64 exec, s[32:33]
    buffer_store_dwordx4 v[212:215], v26, s[12:15], s6 offen sc1
    s_mov_b64 exec, s[62:63]
    s_waitcnt lgkmcnt(10)
    buffer_store_dwordx4 v[188:191], v5, s[12:15], s47 offen offset:0 sc1
    s_mov_b64 exec, -1
    v_add_u32 v26, 16384, v26
    v_pk_add_f32 v[48:49], v[48:49], v[56:57]
    v_pk_add_f32 v[50:51], v[50:51], v[58:59]
    v_pk_add_f32 v[64:65], v[64:65], v[168:169]
    v_pk_add_f32 v[66:67], v[66:67], v[170:171]
    ds_write_b128 v16, v[48:51] offset:20736
    v_mov_b32 v168, v64
    v_mov_b32 v169, v65
    v_mov_b32 v170, v66
    v_mov_b32 v171, v67
    v_permlane16_swap_b32 v168, v64
    v_permlane16_swap_b32 v169, v65
    v_permlane16_swap_b32 v170, v66
    s_mov_b64 exec, s[32:33]
    buffer_store_dwordx4 v[216:219], v26, s[12:15], s6 offen sc1
    s_mov_b64 exec, s[62:63]
    s_waitcnt lgkmcnt(9)
    buffer_store_dwordx4 v[192:195], v5, s[12:15], s47 offen offset:1024 sc1
    s_mov_b64 exec, -1
    v_add_u32 v26, 16384, v26
    v_permlane16_swap_b32 v171, v67
    v_pk_add_f32 v[64:65], v[64:65], v[168:169]
    v_pk_add_f32 v[66:67], v[66:67], v[170:171]
    ds_write_b128 v18, v[64:67] offset:20736
    s_waitcnt lgkmcnt(0)
    s_barrier
    ds_read2st64_b32 v[48:49], v19 offset0:10 offset1:11
    ds_read2st64_b32 v[50:51], v19 offset0:0 offset1:1
    ds_read2st64_b32 v[52:53], v19 offset0:12 offset1:13
    ds_read2st64_b32 v[54:55], v19 offset0:2 offset1:3
    ds_read2st64_b32 v[56:57], v19 offset0:14 offset1:15
    ds_read2st64_b32 v[58:59], v19 offset0:4 offset1:5
    ds_read2st64_b32 v[60:61], v19 offset0:16 offset1:17
    s_mov_b64 exec, s[32:33]
    buffer_store_dwordx4 v[220:223], v26, s[12:15], s6 offen sc1
    s_mov_b64 exec, s[62:63]
    buffer_store_dwordx4 v[196:199], v5, s[12:15], s47 offen offset:2048 sc1
    s_mov_b64 exec, -1
    v_add_u32 v26, 16384, v26
    ds_read2st64_b32 v[62:63], v19 offset0:6 offset1:7
    ds_read2st64_b32 v[64:65], v19 offset0:18 offset1:19
    ds_read2st64_b32 v[66:67], v19 offset0:8 offset1:9
    s_waitcnt lgkmcnt(8)
    v_pk_fma_f32 v[28:29], v[28:29], v[48:49], v[50:51] op_sel_hi:[1,0,0]
    v_fma_f32 v30, v30, v49, v51
    v_fma_f32 v31, v31, v49, v51
    v_cvt_pk_bf16_f32 v176, v28, v29
    s_waitcnt lgkmcnt(6)
    v_pk_fma_f32 v[32:33], v[32:33], v[52:53], v[54:55] op_sel_hi:[1,0,0]
    v_cvt_pk_bf16_f32 v177, v30, v31
    v_fma_f32 v34, v34, v53, v55
    v_fma_f32 v35, v35, v53, v55
    v_cvt_pk_bf16_f32 v178, v32, v33
    s_mov_b64 exec, s[32:33]
    buffer_store_dwordx4 v[224:227], v26, s[12:15], s6 offen sc1
    s_mov_b64 exec, s[62:63]
    buffer_store_dwordx4 v[200:203], v5, s[12:15], s48 offen offset:0 sc1
    s_mov_b64 exec, -1
    v_add_u32 v26, 16384, v26
    s_waitcnt lgkmcnt(4)
    v_pk_fma_f32 v[36:37], v[36:37], v[56:57], v[58:59] op_sel_hi:[1,0,0]
    v_cvt_pk_bf16_f32 v179, v34, v35
    v_fma_f32 v38, v38, v57, v59
    v_fma_f32 v39, v39, v57, v59
    v_cvt_pk_bf16_f32 v180, v36, v37
    s_waitcnt lgkmcnt(2)
    v_pk_fma_f32 v[40:41], v[40:41], v[60:61], v[62:63] op_sel_hi:[1,0,0]
    v_cvt_pk_bf16_f32 v181, v38, v39
    v_fma_f32 v42, v42, v61, v63
    v_fma_f32 v43, v43, v61, v63
    v_cvt_pk_bf16_f32 v182, v40, v41
    s_waitcnt lgkmcnt(0)
    v_pk_fma_f32 v[44:45], v[44:45], v[64:65], v[66:67] op_sel_hi:[1,0,0]
    v_cvt_pk_bf16_f32 v183, v42, v43
    s_mov_b64 exec, s[32:33]
    buffer_store_dwordx4 v[228:231], v26, s[12:15], s6 offen sc1
    s_mov_b64 exec, s[62:63]
    buffer_store_dwordx4 v[204:207], v5, s[12:15], s48 offen offset:1024 sc1
    s_mov_b64 exec, -1
    v_add_u32 v26, 2555904, v26
    v_mov_b32 v21, 0x7f000000
    v_cndmask_b32 v26, v21, v26, s[28:29]
    v_fma_f32 v46, v46, v65, v67
    v_fma_f32 v47, v47, v65, v67
    v_cvt_pk_bf16_f32 v184, v44, v45
    v_cvt_pk_bf16_f32 v185, v46, v47
    v_mfma_f32_16x16x32_bf16 v[28:31], v[176:179], v[68:71], 0
    v_mfma_f32_16x16x32_bf16 v[32:35], v[176:179], v[78:81], 0
    v_mfma_f32_16x16x32_bf16 v[28:31], v[180:183], v[72:75], v[28:31]
    v_mfma_f32_16x16x32_bf16 v[32:35], v[180:183], v[82:85], v[32:35]
    v_mfma_f32_16x16x32_bf16 v[28:31], v[184:187], v[76:79], v[28:31]
    v_mfma_f32_16x16x32_bf16 v[32:35], v[184:187], v[86:89], v[32:35]
    v_mfma_f32_16x16x32_bf16 v[36:39], v[176:179], v[88:91], 0
    v_mfma_f32_16x16x32_bf16 v[40:43], v[176:179], v[98:101], 0
    s_mov_b64 exec, s[32:33]
    buffer_store_dwordx4 v[232:235], v26, s[12:15], s6 offen sc1
    s_mov_b64 exec, s[62:63]
    buffer_store_dwordx4 v[208:211], v5, s[12:15], s48 offen offset:2048 sc1
    s_mov_b64 exec, -1
    v_mfma_f32_16x16x32_bf16 v[36:39], v[180:183], v[92:95], v[36:39]
    v_mfma_f32_16x16x32_bf16 v[40:43], v[180:183], v[102:105], v[40:43]
    v_mfma_f32_16x16x32_bf16 v[36:39], v[184:187], v[96:99], v[36:39]
    v_mfma_f32_16x16x32_bf16 v[40:43], v[184:187], v[106:109], v[40:43]
    v_mfma_f32_16x16x32_bf16 v[44:47], v[176:179], v[108:111], 0
    v_mfma_f32_16x16x32_bf16 v[48:51], v[176:179], v[118:121], 0
    v_mfma_f32_16x16x32_bf16 v[44:47], v[180:183], v[112:115], v[44:47]
    v_mfma_f32_16x16x32_bf16 v[48:51], v[180:183], v[122:125], v[48:51]
    v_mfma_f32_16x16x32_bf16 v[44:47], v[184:187], v[116:119], v[44:47]
    v_mfma_f32_16x16x32_bf16 v[48:51], v[184:187], v[126:129], v[48:51]
    v_pk_mul_f32 v[168:169], v[28:29], v[136:137]
    v_pk_mul_f32 v[172:173], v[32:33], v[136:137]
    s_mov_b64 exec, s[90:91]
    buffer_store_dwordx4 v[246:249], v5, s[12:15], s49 offen offset:0 sc1
    s_mov_b64 exec, -1
    v_pk_mul_f32 v[170:171], v[30:31], v[138:139]
    v_pk_mul_f32 v[174:175], v[34:35], v[138:139]
    v_pk_fma_f32 v[168:169], v[32:33], v[148:149], v[168:169]
    v_pk_fma_f32 v[172:173], v[28:29], v[148:149], v[172:173] neg_lo:[0,1,0] neg_hi:[0,1,0]
    v_pk_fma_f32 v[170:171], v[34:35], v[150:151], v[170:171]
    v_pk_fma_f32 v[174:175], v[30:31], v[150:151], v[174:175] neg_lo:[0,1,0] neg_hi:[0,1,0]
    v_cvt_pk_bf16_f32 v52, v168, v169
    v_cvt_pk_bf16_f32 v53, v170, v171
    v_cvt_pk_bf16_f32 v54, v172, v173
    v_cvt_pk_bf16_f32 v55, v174, v175
    s_nop 1
    v_mfma_f32_16x16x32_bf16 v[68:71], v[160:163], v[52:55], 0
    v_mfma_f32_16x16x32_bf16 v[72:75], v[164:167], v[52:55], 0
    s_mov_b64 exec, s[90:91]
    buffer_store_dwordx4 v[246:249], v5, s[12:15], s49 offen offset:1024 sc1
    s_mov_b64 exec, -1
    v_pk_mul_f32 v[168:169], v[36:37], v[140:141]
    v_pk_mul_f32 v[172:173], v[40:41], v[140:141]
    v_pk_mul_f32 v[170:171], v[38:39], v[142:143]
    v_pk_mul_f32 v[174:175], v[42:43], v[142:143]
    v_pk_fma_f32 v[168:169], v[40:41], v[152:153], v[168:169]
    v_pk_fma_f32 v[172:173], v[36:37], v[152:153], v[172:173] neg_lo:[0,1,0] neg_hi:[0,1,0]
    v_pk_fma_f32 v[170:171], v[42:43], v[154:155], v[170:171]
    v_pk_fma_f32 v[174:175], v[38:39], v[154:155], v[174:175] neg_lo:[0,1,0] neg_hi:[0,1,0]
    v_cvt_pk_bf16_f32 v56, v168, v169
    v_cvt_pk_bf16_f32 v57, v170, v171
    v_cvt_pk_bf16_f32 v58, v172, v173
    v_cvt_pk_bf16_f32 v59, v174, v175
    s_mov_b64 exec, s[90:91]
    buffer_store_dwordx4 v[246:249], v5, s[12:15], s49 offen offset:2048 sc1
    s_mov_b64 exec, -1
    v_mfma_f32_16x16x32_bf16 v[76:79], v[160:163], v[56:59], 0
    v_mfma_f32_16x16x32_bf16 v[80:83], v[164:167], v[56:59], 0
    ds_write_b64 v12, v[68:69] offset:0
    ds_write_b64 v12, v[70:71] offset:320
    ds_write_b64 v12, v[72:73] offset:2560
    ds_write_b64 v12, v[74:75] offset:2880
    v_pk_mul_f32 v[168:169], v[44:45], v[144:145]
    v_pk_mul_f32 v[172:173], v[48:49], v[144:145]
    v_pk_mul_f32 v[170:171], v[46:47], v[146:147]
    v_pk_mul_f32 v[174:175], v[50:51], v[146:147]
    v_pk_fma_f32 v[168:169], v[48:49], v[156:157], v[168:169]
    v_pk_fma_f32 v[172:173], v[44:45], v[156:157], v[172:173] neg_lo:[0,1,0] neg_hi:[0,1,0]
    s_mov_b64 exec, s[90:91]
    buffer_store_dwordx4 v[246:249], v5, s[12:15], s49 offen offset:3072 sc1
    s_mov_b64 exec, -1
    v_pk_fma_f32 v[170:171], v[50:51], v[158:159], v[170:171]
    v_pk_fma_f32 v[174:175], v[46:47], v[158:159], v[174:175] neg_lo:[0,1,0] neg_hi:[0,1,0]
    v_cvt_pk_bf16_f32 v60, v168, v169
    v_cvt_pk_bf16_f32 v61, v170, v171
    v_cvt_pk_bf16_f32 v62, v172, v173
    v_cvt_pk_bf16_f32 v63, v174, v175
    s_nop 1
    v_mfma_f32_16x16x32_bf16 v[84:87], v[160:163], v[60:63], 0
    v_mfma_f32_16x16x32_bf16 v[88:91], v[164:167], v[60:63], 0
    ds_write_b64 v12, v[76:77] offset:128
    ds_write_b64 v12, v[78:79] offset:448
    ds_write_b64 v12, v[80:81] offset:2688
    ds_write_b64 v12, v[82:83] offset:3008
    s_mov_b64 exec, 1
    ds_write_b64 v12, v[68:69] offset:5120
    s_mov_b32 exec_lo, 0x00ff00ff
    s_mov_b32 exec_hi, 0x00ff00ff
    ds_write_b64 v12, v[84:85] offset:256
    ds_write_b64 v12, v[86:87] offset:576
    ds_write_b64 v12, v[88:89] offset:2816
    ds_write_b64 v12, v[90:91] offset:3136
    s_mov_b64 exec, -1
    s_waitcnt lgkmcnt(0)
    s_barrier
    s_mov_b32 s11, 49152
    buffer_load_dwordx4 v[252:255], v5, s[12:15], s11 offen sc1
    ds_read_b64 v[28:29], v13 offset:0
    ds_read_b64 v[30:31], v14 offset:2048
    ds_read_b64 v[32:33], v13 offset:5184
    ds_read_b64 v[34:35], v14 offset:7232
    ds_read_b64 v[36:37], v13 offset:1024
    ds_read_b64 v[38:39], v14 offset:1024
    ds_read_b64 v[40:41], v13 offset:6208
    ds_read_b64 v[42:43], v14 offset:6208
    ds_read_b64 v[44:45], v13 offset:2048
    ds_read_b64 v[46:47], v14 offset:0
    ds_read_b64 v[48:49], v13 offset:7232
    ds_read_b64 v[50:51], v14 offset:5184
    s_waitcnt lgkmcnt(10)
    v_pk_add_f32 v[168:169], v[28:29], v[30:31]
    v_pk_add_f32 v[170:171], v[28:29], v[30:31] neg_lo:[0,1] neg_hi:[0,1]
    s_waitcnt lgkmcnt(8)
    v_pk_add_f32 v[172:173], v[32:33], v[34:35]
    v_pk_add_f32 v[174:175], v[32:33], v[34:35] neg_lo:[0,1] neg_hi:[0,1]
    v_cvt_pk_bf16_f32 v52, v168, v169
    v_cvt_pk_bf16_f32 v54, v171, -v170
    v_cvt_pk_bf16_f32 v53, v172, v173
    v_cvt_pk_bf16_f32 v55, v175, -v174
    v_or_b32 v52, 1, v52
    buffer_store_dwordx4 v[52:55], v15, s[40:43], 0 offen sc1
    s_waitcnt lgkmcnt(6)
    v_pk_add_f32 v[168:169], v[36:37], v[38:39]
    v_pk_add_f32 v[170:171], v[36:37], v[38:39] neg_lo:[0,1] neg_hi:[0,1]
    s_waitcnt lgkmcnt(4)
    v_pk_add_f32 v[172:173], v[40:41], v[42:43]
    v_pk_add_f32 v[174:175], v[40:41], v[42:43] neg_lo:[0,1] neg_hi:[0,1]
    v_cvt_pk_bf16_f32 v56, v168, v169
    v_cvt_pk_bf16_f32 v58, v171, -v170
    v_cvt_pk_bf16_f32 v57, v172, v173
    v_cvt_pk_bf16_f32 v59, v175, -v174
    v_or_b32 v56, 1, v56
    buffer_store_dwordx4 v[56:59], v15, s[40:43], s38 offen sc1
    s_waitcnt lgkmcnt(2)
    v_pk_add_f32 v[168:169], v[44:45], v[46:47]
    v_pk_add_f32 v[170:171], v[44:45], v[46:47] neg_lo:[0,1] neg_hi:[0,1]
    s_waitcnt lgkmcnt(0)
    v_pk_add_f32 v[172:173], v[48:49], v[50:51]
    v_pk_add_f32 v[174:175], v[48:49], v[50:51] neg_lo:[0,1] neg_hi:[0,1]
    v_cvt_pk_bf16_f32 v60, v168, v169
    v_cvt_pk_bf16_f32 v62, v171, -v170
    v_cvt_pk_bf16_f32 v61, v172, v173
    v_cvt_pk_bf16_f32 v63, v175, -v174
    v_or_b32 v60, 1, v60
    buffer_store_dwordx4 v[60:63], v15, s[40:43], s39 offen sc1
    s_load_dwordx2 s[4:5], s[0:1], 88
    s_load_dwordx2 s[40:41], s[0:1], 72
    s_load_dwordx2 s[62:63], s[0:1], 48
    s_cmp_ge_u32 s2, 161
    s_cbranch_scc1 LWD
    v_lshlrev_b32 v12, 3, v4
    s_lshl_b32 s48, s2, 14
    s_lshl_b32 s49, s22, 11
    s_add_u32 s49, s49, s48
    s_lshl_b32 s24, s22, 11
    s_add_u32 s48, s48, s24
    s_add_u32 s90, s24, 81920
    s_mov_b32 m0, s90
    s_cmp_eq_u32 s2, 0
    s_cselect_b32 s50, 0, 1.0
    s_cmp_eq_u32 s2, 160
    s_cselect_b32 s50, 0, s50
    s_mov_b32 s52, 0x80008000
    v_lshlrev_b32 v22, 31, v7
    v_or_b32 v22, 1.0, v22
    v_cvt_f32_u32 v16, v7
    v_lshlrev_b32 v17, 2, v8
    v_cvt_f32_u32 v17, v17
    v_lshlrev_b32 v19, 4, v1
    v_cvt_f32_u32 v19, v19
    v_add_f32 v18, v19, v16
    v_mul_f32 v20, 0x3c800000, v18
    v_mul_f32 v21, v17, v20
    v_fmamk_f32 v180, v20, 0x00000000, v21
    v_fmamk_f32 v181, v20, 0x3f800000, v21
    v_fmamk_f32 v182, v20, 0x40000000, v21
    v_fmamk_f32 v183, v20, 0x40400000, v21
    v_cos_f32 v176, v180
    v_sin_f32 v180, v180
    v_cos_f32 v177, v181
    v_sin_f32 v181, v181
    v_cos_f32 v178, v182
    v_sin_f32 v182, v182
    v_cos_f32 v179, v183
    v_sin_f32 v183, v183
    v_cvt_pk_bf16_f32 v24, -v180, -v181
    v_cvt_pk_bf16_f32 v26, v176, v177
    v_cvt_pk_bf16_f32 v28, v180, v181
    v_cvt_pk_bf16_f32 v25, -v182, -v183
    v_cvt_pk_bf16_f32 v27, v178, v179
    v_cvt_pk_bf16_f32 v29, v182, v183
    v_pk_mul_f32 v[176:177], v[176:177], v[22:23] op_sel_hi:[1,0]
    v_pk_mul_f32 v[180:181], v[180:181], v[22:23] op_sel_hi:[1,0]
    v_pk_mul_f32 v[178:179], v[178:179], v[22:23] op_sel_hi:[1,0]
    v_pk_mul_f32 v[182:183], v[182:183], v[22:23] op_sel_hi:[1,0]
    v_cvt_pk_bf16_f32 v36, -v180, -v181
    v_cvt_pk_bf16_f32 v38, v176, v177
    v_cvt_pk_bf16_f32 v40, v180, v181
    v_cvt_pk_bf16_f32 v37, -v182, -v183
    v_cvt_pk_bf16_f32 v39, v178, v179
    v_cvt_pk_bf16_f32 v41, v182, v183
    s_waitcnt lgkmcnt(0)
    s_add_u32 s44, s4, 2752512
    s_addc_u32 s45, s5, 0
    s_mov_b32 s46, 2637824
    s_mov_b32 s47, 0x00020000
    s_waitcnt vmcnt(4)
    s_barrier
    v_mov_b32 v250, s100
    v_mov_b32 v251, 0
    s_lshl_b32 s98, s2, 2
    s_add_u32 s98, s98, 50176
    s_cmp_eq_u32 s22, 3
    s_cselect_b64 exec, 1, 0
    buffer_store_dword v250, v251, s[12:15], s98 offen sc1
    s_mov_b64 exec, -1
    s_and_b32 s20, s2, 6
    s_lshl_b32 s20, s20, 1
    s_lshr_b32 s21, s2, 6
    s_add_u32 s20, s20, s21
    s_bfe_u32 s56, s2, 0x30003
    s_and_b32 s57, s2, 1
    s_lshl_b32 s21, s57, 3
    s_add_u32 s21, s21, s56
    s_lshl_b32 s25, s20, 4
    s_add_u32 s3, s25, s21
    s_lshr_b32 s25, s20, 2
    s_lshl_b32 s25, s25, 12
    s_lshl_b32 s24, s57, 11
    s_add_u32 s25, s25, s24
    s_and_b32 s24, s21, 1
    s_lshl_b32 s24, s24, 10
    s_add_u32 s25, s25, s24
    s_and_b32 s24, s20, 3
    s_lshl_b32 s24, s24, 8
    s_add_u32 s25, s25, s24
    s_and_b32 s24, s21, 6
    s_lshl_b32 s24, s24, 5
    s_add_u32 s25, s25, s24
    s_add_u32 s26, s25, 1048576
    s_add_u32 s27, s25, 2097152
    s_mul_i32 s30, s22, 2560
    s_add_u32 s30, s30, 32768
    s_lshl_b32 s31, s22, 11
    s_add_u32 s88, s31, 43008
    s_add_u32 s31, s31, 5120
    s_lshl_b32 s32, s21, 2
    s_add_u32 s32, s32, s22
    s_mul_i32 s24, s32, 30720
    s_add_u32 s24, s24, 19005440
    v_add_u32 v6, s24, v5
    s_mul_i32 s58, s20, 393216
    s_mul_i32 s24, s32, 768
    s_add_u32 s58, s58, s24
    s_add_u32 s58, s58, 10747904
    s_add_u32 s59, s58, 98304
    s_add_u32 s60, s58, 196608
    s_add_u32 s61, s58, 294912
    s_and_b32 s89, s2, 7
    s_lshl_b32 s89, s89, 7
    s_add_u32 s89, s89, 45056
    s_mov_b32 s12, s4
    s_mov_b32 s13, s5
    s_mov_b32 s14, 25714688
    s_mov_b32 s15, 0x00020000
    s_add_u32 s16, s4, 65536
    s_addc_u32 s17, s5, 0
    s_mov_b32 s18, 2637824
    s_mov_b32 s19, 0x00020000
    s_lshl_b32 s53, s22, 12
    s_lshl_b32 s24, s2, 14
    s_add_u32 s53, s53, s24
    v_mul_f32 v20, 0x3c800000, v18
    v_mul_f32 v21, v17, v20
    v_fmamk_f32 v180, v20, 0x41800000, v21
    v_fmamk_f32 v181, v20, 0x41880000, v21
    v_fmamk_f32 v182, v20, 0x41900000, v21
    v_fmamk_f32 v183, v20, 0x41980000, v21
    v_cos_f32 v176, v180
    v_sin_f32 v180, v180
    v_cos_f32 v177, v181
    v_sin_f32 v181, v181
    v_cos_f32 v178, v182
    v_sin_f32 v182, v182
    v_cos_f32 v179, v183
    v_sin_f32 v183, v183
    v_cvt_pk_bf16_f32 v30, -v180, -v181
    v_cvt_pk_bf16_f32 v32, v176, v177
    v_cvt_pk_bf16_f32 v34, v180, v181
    v_cvt_pk_bf16_f32 v31, -v182, -v183
    v_cvt_pk_bf16_f32 v33, v178, v179
    v_cvt_pk_bf16_f32 v35, v182, v183
    v_pk_mul_f32 v[176:177], v[176:177], v[22:23] op_sel_hi:[1,0]
    v_pk_mul_f32 v[180:181], v[180:181], v[22:23] op_sel_hi:[1,0]
    v_pk_mul_f32 v[178:179], v[178:179], v[22:23] op_sel_hi:[1,0]
    v_pk_mul_f32 v[182:183], v[182:183], v[22:23] op_sel_hi:[1,0]
    v_cvt_pk_bf16_f32 v42, -v180, -v181
    v_cvt_pk_bf16_f32 v44, v176, v177
    v_cvt_pk_bf16_f32 v46, v180, v181
    v_cvt_pk_bf16_f32 v43, -v182, -v183
    v_cvt_pk_bf16_f32 v45, v178, v179
    v_cvt_pk_bf16_f32 v47, v182, v183
    v_mul_f32 v20, 0x3a000000, v18
    v_mul_f32 v21, v17, v20
    v_fmamk_f32 v80, v20, 0x00000000, v21
    v_fmamk_f32 v81, v20, 0x3f800000, v21
    v_fmamk_f32 v82, v20, 0x40000000, v21
    v_fmamk_f32 v83, v20, 0x40400000, v21
    v_cos_f32 v72, v80
    v_sin_f32 v80, v80
    v_cos_f32 v73, v81
    v_sin_f32 v81, v81
    v_cos_f32 v74, v82
    v_sin_f32 v82, v82
    v_cos_f32 v75, v83
    v_sin_f32 v83, v83
    v_mul_f32 v20, 0x3a000000, v18
    v_mul_f32 v21, v17, v20
    v_fmamk_f32 v84, v20, 0x41800000, v21
    v_fmamk_f32 v85, v20, 0x41880000, v21
    v_fmamk_f32 v86, v20, 0x41900000, v21
    v_fmamk_f32 v87, v20, 0x41980000, v21
    v_cos_f32 v76, v84
    v_sin_f32 v84, v84
    v_cos_f32 v77, v85
    v_sin_f32 v85, v85
    v_cos_f32 v78, v86
    v_sin_f32 v86, v86
    v_cos_f32 v79, v87
    v_sin_f32 v87, v87
    v_mul_f32 v20, 0x3d000000, v16
    v_mul_f32 v21, v17, v20
    v_fmamk_f32 v180, v20, 0x00000000, v21
    v_fmamk_f32 v181, v20, 0x3f800000, v21
    v_fmamk_f32 v182, v20, 0x40000000, v21
    v_fmamk_f32 v183, v20, 0x40400000, v21
    v_cos_f32 v176, v180
    v_sin_f32 v180, v180
    v_cos_f32 v177, v181
    v_sin_f32 v181, v181
    v_cos_f32 v178, v182
    v_sin_f32 v182, v182
    v_cos_f32 v179, v183
    v_sin_f32 v183, v183
    v_cvt_pk_bf16_f32 v48, -v180, -v181
    v_cvt_pk_bf16_f32 v50, v176, v177
    v_cvt_pk_bf16_f32 v52, v180, v181
    v_cvt_pk_bf16_f32 v49, -v182, -v183
    v_cvt_pk_bf16_f32 v51, v178, v179
    v_cvt_pk_bf16_f32 v53, v182, v183
    v_cvt_pk_bf16_f32 v60, -v180, v181
    v_cvt_pk_bf16_f32 v62, v176, -v177
    v_cvt_pk_bf16_f32 v64, v180, -v181
    v_cvt_pk_bf16_f32 v61, -v182, v183
    v_cvt_pk_bf16_f32 v63, v178, -v179
    v_cvt_pk_bf16_f32 v65, v182, -v183
    v_pk_mul_f32 v[176:177], v[176:177], v[22:23] op_sel_hi:[1,0]
    v_pk_mul_f32 v[180:181], v[180:181], v[22:23] op_sel_hi:[1,0]
    v_pk_mul_f32 v[178:179], v[178:179], v[22:23] op_sel_hi:[1,0]
    v_pk_mul_f32 v[182:183], v[182:183], v[22:23] op_sel_hi:[1,0]
    v_cvt_pk_bf16_f32 v54, -v180, -v181
    v_cvt_pk_bf16_f32 v56, v176, v177
    v_cvt_pk_bf16_f32 v58, v180, v181
    v_cvt_pk_bf16_f32 v55, -v182, -v183
    v_cvt_pk_bf16_f32 v57, v178, v179
    v_cvt_pk_bf16_f32 v59, v182, v183
    v_cvt_pk_bf16_f32 v66, -v180, v181
    v_cvt_pk_bf16_f32 v68, v176, -v177
    v_cvt_pk_bf16_f32 v70, v180, -v181
    v_cvt_pk_bf16_f32 v67, -v182, v183
    v_cvt_pk_bf16_f32 v69, v178, -v179
    v_cvt_pk_bf16_f32 v71, v182, -v183
    v_add_f32 v19, v19, v17
    v_mul_f32 v20, 0x3a000000, v16
    v_mul_f32 v21, v19, v20
    v_fmamk_f32 v96, v20, 0x00000000, v21
    v_fmamk_f32 v97, v20, 0x3f800000, v21
    v_fmamk_f32 v98, v20, 0x40000000, v21
    v_fmamk_f32 v99, v20, 0x40400000, v21
    v_cos_f32 v88, v96
    v_sin_f32 v96, v96
    v_cos_f32 v89, v97
    v_sin_f32 v97, v97
    v_cos_f32 v90, v98
    v_sin_f32 v98, v98
    v_cos_f32 v91, v99
    v_sin_f32 v99, v99
    v_add_f32 v16, 0x41800000, v16
    v_mul_f32 v20, 0x3a000000, v16
    v_mul_f32 v21, v19, v20
    v_fmamk_f32 v100, v20, 0x00000000, v21
    v_fmamk_f32 v101, v20, 0x3f800000, v21
    v_fmamk_f32 v102, v20, 0x40000000, v21
    v_fmamk_f32 v103, v20, 0x40400000, v21
    v_cos_f32 v92, v100
    v_sin_f32 v100, v100
    v_cos_f32 v93, v101
    v_sin_f32 v101, v101
    v_cos_f32 v94, v102
    v_sin_f32 v102, v102
    v_cos_f32 v95, v103
    v_sin_f32 v103, v103
    v_add_u32 v15, 81920, v5
    v_add_u32 v14, s90, v5
    v_and_b32 v11, 0x3e0, v5
    v_add_u32 v11, v11, v15
    v_and_b32 v12, 2, v7
    v_mul_u32_u24 v13, 4096, v12
    v_add_u32 v13, v13, v15
    v_cmp_eq_u32 vcc, 0, v12
    v_mov_b32 v18, s50
    s_nop 0
    v_cndmask_b32 v18, 1.0, v18, vcc
    v_lshrrev_b32 v232, 5, v4
    v_bfe_u32 v233, v4, 2, 3
    v_lshl_add_u32 v232, v232, 4, v233
    v_mul_u32_u24 v232, 10368, v232
    v_and_b32 v233, 3, v4
    v_lshl_add_u32 v232, v233, 4, v232
    s_mul_i32 s36, s22, 663552
    s_lshl_b32 s24, s2, 6
    s_add_u32 s36, s36, s24
    s_add_u32 s36, s36, 23003136
    s_add_u32 s37, s36, 330752
    s_add_u32 s38, s36, 80896
    s_add_u32 s39, s36, 411648
    s_lshl_b32 s48, s22, 12
    s_add_u32 s48, s48, 81920
    v_add_u32 v233, s48, v5
    s_waitcnt vmcnt(4)
    v_xor_b32 v252, s100, v252
    v_xor_b32 v253, s100, v253
    v_xor_b32 v254, s100, v254
    v_xor_b32 v255, s100, v255
    v_or3_b32 v252, v252, v253, v254
    v_or_b32 v252, v252, v255
    v_cmp_ne_u32 s[98:99], 0, v252
    s_nop 0
    s_cmp_lg_u64 s[98:99], 0
    s_nop 1
    s_cbranch_scc1 LA0c_slow
LA0c_ok:
    s_mov_b32 m0, s48
    s_nop 0
    buffer_load_dwordx4 v232, s[12:15], s36 offen offset:0 sc1 lds
    buffer_load_dwordx4 v232, s[12:15], s37 offen offset:1024 sc1 lds
    buffer_load_dwordx4 v232, s[12:15], s38 offen offset:2048 sc1 lds
    buffer_load_dwordx4 v232, s[12:15], s39 offen offset:3072 sc1 lds
    s_waitcnt vmcnt(0)
    ds_read2st64_b32 v[234:235], v233 offset0:0 offset1:4
    ds_read2st64_b32 v[236:237], v233 offset0:8 offset1:12
    s_waitcnt lgkmcnt(0)
    v_bitop3_b32 v234, v234, v235, v236 bitop3:0x80
    v_bitop3_b32 v234, v234, v237, 1 bitop3:0x80
    v_cmp_eq_u32 s[98:99], 0, v234
    s_nop 0
    s_cmp_lg_u64 s[98:99], 0
    s_nop 1
    s_cbranch_scc1 LXG_slow
LXG_ok:
    v_mov_b32 v251, 0
    s_and_b32 s101, s2, 7
    s_lshl_b32 s101, s101, 7
    s_add_u32 s101, s101, 52224
    buffer_load_dword v249, v251, s[12:15], s101 offen sc1
    s_barrier
    ds_read_b128 v[120:123], v11 offset:0
    ds_read_b128 v[128:131], v11 offset:4096
    ds_read_b128 v[136:139], v11 offset:8192
    ds_read_b128 v[144:147], v11 offset:12288
    ds_read_b128 v[124:127], v11 offset:2048
    ds_read_b128 v[132:135], v11 offset:6144
    ds_read_b128 v[140:143], v11 offset:10240
    ds_read_b128 v[148:151], v11 offset:14336
    ds_read_b128 v[184:187], v11 offset:32
    ds_read_b128 v[192:195], v11 offset:4128
    ds_read_b128 v[200:203], v11 offset:8224
    ds_read_b128 v[208:211], v11 offset:12320
    ds_read_b128 v[188:191], v11 offset:2080
    ds_read_b128 v[196:199], v11 offset:6176
    ds_read_b128 v[204:207], v11 offset:10272
    s_waitcnt lgkmcnt(14)
    v_mfma_f32_16x16x32_bf16 v[152:155], v[120:123], v[26:29], 0
    ds_read_b128 v[212:215], v11 offset:14368
    v_mfma_f32_16x16x32_bf16 v[156:159], v[120:123], v[24:27], 0
    s_waitcnt lgkmcnt(14)
    v_mfma_f32_16x16x32_bf16 v[152:155], v[128:131], v[32:35], v[152:155]
    v_mfma_f32_16x16x32_bf16 v[156:159], v[128:131], v[30:33], v[156:159]
    s_waitcnt lgkmcnt(13)
    v_mfma_f32_16x16x32_bf16 v[152:155], v[136:139], v[38:41], v[152:155]
    v_mfma_f32_16x16x32_bf16 v[156:159], v[136:139], v[36:39], v[156:159]
    s_waitcnt lgkmcnt(12)
    v_mfma_f32_16x16x32_bf16 v[152:155], v[144:147], v[44:47], v[152:155]
    v_mfma_f32_16x16x32_bf16 v[156:159], v[144:147], v[42:45], v[156:159]
    s_waitcnt lgkmcnt(11)
    v_mfma_f32_16x16x32_bf16 v[160:163], v[124:127], v[26:29], 0
    v_mfma_f32_16x16x32_bf16 v[164:167], v[124:127], v[24:27], 0
    s_waitcnt lgkmcnt(10)
    v_mfma_f32_16x16x32_bf16 v[160:163], v[132:135], v[32:35], v[160:163]
    v_mfma_f32_16x16x32_bf16 v[164:167], v[132:135], v[30:33], v[164:167]
    s_waitcnt lgkmcnt(9)
    v_mfma_f32_16x16x32_bf16 v[160:163], v[140:143], v[38:41], v[160:163]
    v_mfma_f32_16x16x32_bf16 v[164:167], v[140:143], v[36:39], v[164:167]
    s_waitcnt lgkmcnt(8)
    v_mfma_f32_16x16x32_bf16 v[160:163], v[148:151], v[44:47], v[160:163]
    v_mfma_f32_16x16x32_bf16 v[164:167], v[148:151], v[42:45], v[164:167]
    s_waitcnt lgkmcnt(7)
    v_mfma_f32_16x16x32_bf16 v[216:219], v[184:187], v[26:29], 0
    v_mfma_f32_16x16x32_bf16 v[220:223], v[184:187], v[24:27], 0
    s_waitcnt lgkmcnt(6)
    v_mfma_f32_16x16x32_bf16 v[216:219], v[192:195], v[32:35], v[216:219]
    v_mfma_f32_16x16x32_bf16 v[220:223], v[192:195], v[30:33], v[220:223]
    s_waitcnt vmcnt(0)
    v_readfirstlane_b32 s98, v249
    s_nop 0
    s_cmp_lg_u32 s98, s100
    s_nop 2
    s_cbranch_scc1 LG1c_slow
LG1c_ok:
    buffer_load_dwordx4 v[104:107], v5, s[44:47], s49 offen offset:0 sc1
    buffer_load_dwordx4 v[108:111], v5, s[44:47], s49 offen offset:1024 sc1
    s_add_u32 s49, s49, 8192
    buffer_load_dwordx4 v[112:115], v5, s[44:47], s49 offen offset:0 sc1
    buffer_load_dwordx4 v[116:119], v5, s[44:47], s49 offen offset:1024 sc1
    s_add_u32 s49, s49, 8192
    v_mov_b32 v252, 0
    v_mov_b32 v253, 0
    v_mov_b32 v254, 0
    v_mov_b32 v255, 0
    v_lshlrev_b32 v248, 4, v0
    s_mul_i32 s51, s2, 205
    s_lshr_b32 s51, s51, 10
    s_mul_i32 s51, s51, 40960
    s_lshl_b32 s24, s2, 13
    s_add_u32 s51, s51, s24
    s_add_u32 s51, s51, 5505024
    s_cmp_lt_u32 s2, 160
    s_cselect_b32 s51, s51, 0x7f000000
    buffer_store_dwordx4 v[252:255], v248, s[12:15], s51 offen sc1
    s_add_u32 s51, s51, 4096
    buffer_store_dwordx4 v[252:255], v248, s[12:15], s51 offen sc1
    s_waitcnt lgkmcnt(5)
    v_mfma_f32_16x16x32_bf16 v[216:219], v[200:203], v[38:41], v[216:219]
    v_pk_mul_f32 v[176:177], v[152:153], v[72:73]
    v_pk_mul_f32 v[180:181], v[156:157], v[72:73]
    v_mfma_f32_16x16x32_bf16 v[220:223], v[200:203], v[36:39], v[220:223]
    v_pk_mul_f32 v[178:179], v[154:155], v[74:75]
    v_pk_mul_f32 v[182:183], v[158:159], v[74:75]
    s_waitcnt lgkmcnt(4)
    v_mfma_f32_16x16x32_bf16 v[216:219], v[208:211], v[44:47], v[216:219]
    v_pk_fma_f32 v[176:177], v[156:157], v[80:81], v[176:177]
    v_pk_fma_f32 v[180:181], v[152:153], v[80:81], v[180:181] neg_lo:[0,1,0] neg_hi:[0,1,0]
    v_mfma_f32_16x16x32_bf16 v[220:223], v[208:211], v[42:45], v[220:223]
    v_pk_fma_f32 v[178:179], v[158:159], v[82:83], v[178:179]
    v_pk_fma_f32 v[182:183], v[154:155], v[82:83], v[182:183] neg_lo:[0,1,0] neg_hi:[0,1,0]
    s_waitcnt lgkmcnt(3)
    v_mfma_f32_16x16x32_bf16 v[224:227], v[188:191], v[26:29], 0
    v_cvt_pk_bf16_f32 v168, v176, v177
    v_cvt_pk_bf16_f32 v169, v178, v179
    v_mfma_f32_16x16x32_bf16 v[228:231], v[188:191], v[24:27], 0
    v_cvt_pk_bf16_f32 v170, v180, v181
    v_cvt_pk_bf16_f32 v171, v182, v183
    buffer_load_dwordx4 a[0:3], v6, s[12:15], 0 offen offset:0 sc1
    s_waitcnt lgkmcnt(2)
    v_mfma_f32_16x16x32_bf16 v[224:227], v[196:199], v[32:35], v[224:227]
    v_pk_mul_f32 v[176:177], v[160:161], v[76:77]
    v_pk_mul_f32 v[180:181], v[164:165], v[76:77]
    v_mfma_f32_16x16x32_bf16 v[228:231], v[196:199], v[30:33], v[228:231]
    v_pk_mul_f32 v[178:179], v[162:163], v[78:79]
    v_pk_mul_f32 v[182:183], v[166:167], v[78:79]
    s_waitcnt lgkmcnt(1)
    v_mfma_f32_16x16x32_bf16 v[224:227], v[204:207], v[38:41], v[224:227]
    v_pk_fma_f32 v[176:177], v[164:165], v[84:85], v[176:177]
    v_pk_fma_f32 v[180:181], v[160:161], v[84:85], v[180:181] neg_lo:[0,1,0] neg_hi:[0,1,0]
    v_mfma_f32_16x16x32_bf16 v[228:231], v[204:207], v[36:39], v[228:231]
    v_pk_fma_f32 v[178:179], v[166:167], v[86:87], v[178:179]
    v_pk_fma_f32 v[182:183], v[162:163], v[86:87], v[182:183] neg_lo:[0,1,0] neg_hi:[0,1,0]
    s_waitcnt lgkmcnt(0)
    v_mfma_f32_16x16x32_bf16 v[224:227], v[212:215], v[44:47], v[224:227]
    v_cvt_pk_bf16_f32 v172, v176, v177
    v_cvt_pk_bf16_f32 v173, v178, v179
    v_mfma_f32_16x16x32_bf16 v[228:231], v[212:215], v[42:45], v[228:231]
    v_cvt_pk_bf16_f32 v174, v180, v181
    v_cvt_pk_bf16_f32 v175, v182, v183
    buffer_load_dwordx4 a[4:7], v6, s[12:15], 0 offen offset:1024 sc1
    v_mfma_f32_16x16x32_bf16 v[120:123], v[50:53], v[168:171], 0
    v_pk_mul_f32 v[240:241], v[216:217], v[72:73]
    v_pk_mul_f32 v[244:245], v[220:221], v[72:73]
    v_pk_mul_f32 v[242:243], v[218:219], v[74:75]
    v_mfma_f32_16x16x32_bf16 v[124:127], v[48:51], v[168:171], 0
    v_pk_mul_f32 v[246:247], v[222:223], v[74:75]
    v_pk_fma_f32 v[240:241], v[220:221], v[80:81], v[240:241]
    v_pk_fma_f32 v[244:245], v[216:217], v[80:81], v[244:245] neg_lo:[0,1,0] neg_hi:[0,1,0]
    v_mfma_f32_16x16x32_bf16 v[128:131], v[62:65], v[168:171], 0
    v_pk_fma_f32 v[242:243], v[222:223], v[82:83], v[242:243]
    v_pk_fma_f32 v[246:247], v[218:219], v[82:83], v[246:247] neg_lo:[0,1,0] neg_hi:[0,1,0]
    v_cvt_pk_bf16_f32 v232, v240, v241
    v_mfma_f32_16x16x32_bf16 v[132:135], v[60:63], v[168:171], 0
    v_cvt_pk_bf16_f32 v233, v242, v243
    v_cvt_pk_bf16_f32 v234, v244, v245
    v_cvt_pk_bf16_f32 v235, v246, v247
    v_mfma_f32_16x16x32_bf16 v[120:123], v[56:59], v[172:175], v[120:123]
    v_pk_mul_f32 v[240:241], v[224:225], v[76:77]
    buffer_load_dwordx4 a[8:11], v6, s[12:15], 0 offen offset:2048 sc1
    v_pk_mul_f32 v[244:245], v[228:229], v[76:77]
    v_pk_mul_f32 v[242:243], v[226:227], v[78:79]
    v_mfma_f32_16x16x32_bf16 v[124:127], v[54:57], v[172:175], v[124:127]
    v_pk_mul_f32 v[246:247], v[230:231], v[78:79]
    v_pk_fma_f32 v[240:241], v[228:229], v[84:85], v[240:241]
    v_pk_fma_f32 v[244:245], v[224:225], v[84:85], v[244:245] neg_lo:[0,1,0] neg_hi:[0,1,0]
    v_mfma_f32_16x16x32_bf16 v[128:131], v[68:71], v[172:175], v[128:131]
    v_pk_fma_f32 v[242:243], v[230:231], v[86:87], v[242:243]
    v_pk_fma_f32 v[246:247], v[226:227], v[86:87], v[246:247] neg_lo:[0,1,0] neg_hi:[0,1,0]
    v_cvt_pk_bf16_f32 v236, v240, v241
    v_mfma_f32_16x16x32_bf16 v[132:135], v[66:69], v[172:175], v[132:135]
    v_cvt_pk_bf16_f32 v237, v242, v243
    v_cvt_pk_bf16_f32 v238, v244, v245
    v_cvt_pk_bf16_f32 v239, v246, v247
    v_mfma_f32_16x16x32_bf16 v[184:187], v[50:53], v[232:235], 0
    s_waitcnt vmcnt(8)
    v_lshlrev_b32 v152, 16, v104
    v_and_b32 v153, 0xffff0000, v104
    v_lshlrev_b32 v154, 16, v105
    buffer_load_dwordx4 a[12:15], v6, s[12:15], 0 offen offset:3072 sc1
    v_add_u32 v6, 0x1000, v6
    v_mfma_f32_16x16x32_bf16 v[188:191], v[48:51], v[232:235], 0
    v_and_b32 v155, 0xffff0000, v105
    s_waitcnt vmcnt(8)
    v_lshlrev_b32 v156, 16, v108
    v_and_b32 v157, 0xffff0000, v108
    v_mfma_f32_16x16x32_bf16 v[192:195], v[62:65], v[232:235], 0
    v_lshlrev_b32 v158, 16, v109
    v_and_b32 v159, 0xffff0000, v109
    s_waitcnt vmcnt(7)
    v_lshlrev_b32 v160, 16, v112
    v_mfma_f32_16x16x32_bf16 v[196:199], v[60:63], v[232:235], 0
    v_and_b32 v161, 0xffff0000, v112
    v_lshlrev_b32 v162, 16, v113
    v_and_b32 v163, 0xffff0000, v113
    v_mfma_f32_16x16x32_bf16 v[184:187], v[56:59], v[236:239], v[184:187]
    s_waitcnt vmcnt(6)
    v_lshlrev_b32 v164, 16, v116
    v_and_b32 v165, 0xffff0000, v116
    v_lshlrev_b32 v166, 16, v117
    v_mfma_f32_16x16x32_bf16 v[188:191], v[54:57], v[236:239], v[188:191]
    v_and_b32 v167, 0xffff0000, v117
    buffer_load_dwordx4 a[16:19], v6, s[12:15], 0 offen offset:0 sc1
    v_lshlrev_b32 v216, 16, v106
    v_and_b32 v217, 0xffff0000, v106
    v_mfma_f32_16x16x32_bf16 v[192:195], v[68:71], v[236:239], v[192:195]
    v_lshlrev_b32 v218, 16, v107
    v_and_b32 v219, 0xffff0000, v107
    v_lshlrev_b32 v220, 16, v110
    v_mfma_f32_16x16x32_bf16 v[196:199], v[66:69], v[236:239], v[196:199]
    v_and_b32 v221, 0xffff0000, v110
    v_lshlrev_b32 v222, 16, v111
    v_and_b32 v223, 0xffff0000, v111
    v_lshlrev_b32 v224, 16, v114
    v_and_b32 v225, 0xffff0000, v114
    v_lshlrev_b32 v226, 16, v115
    v_and_b32 v227, 0xffff0000, v115
    v_lshlrev_b32 v228, 16, v118
    v_and_b32 v229, 0xffff0000, v118
    v_lshlrev_b32 v230, 16, v119
    v_and_b32 v231, 0xffff0000, v119
    buffer_load_dwordx4 a[20:23], v6, s[12:15], 0 offen offset:1024 sc1
    v_pk_mul_f32 v[176:177], v[120:121], v[152:153]
    v_pk_mul_f32 v[180:181], v[124:125], v[152:153]
    v_pk_mul_f32 v[178:179], v[122:123], v[154:155]
    v_pk_mul_f32 v[182:183], v[126:127], v[154:155]
    v_pk_fma_f32 v[176:177], v[124:125], v[160:161], v[176:177] neg_lo:[0,1,0] neg_hi:[0,1,0]
    v_pk_fma_f32 v[180:181], v[120:121], v[160:161], v[180:181]
    v_pk_fma_f32 v[178:179], v[126:127], v[162:163], v[178:179] neg_lo:[0,1,0] neg_hi:[0,1,0]
    v_pk_fma_f32 v[182:183], v[122:123], v[162:163], v[182:183]
    v_cvt_pk_bf16_f32 v136, v176, v177
    v_cvt_pk_bf16_f32 v137, v178, v179
    v_cvt_pk_bf16_f32 v138, v180, v181
    v_cvt_pk_bf16_f32 v139, v182, v183
    v_pk_mul_f32 v[176:177], v[128:129], v[156:157]
    v_pk_mul_f32 v[180:181], v[132:133], v[156:157]
    v_pk_mul_f32 v[178:179], v[130:131], v[158:159]
    v_pk_mul_f32 v[182:183], v[134:135], v[158:159]
    v_pk_fma_f32 v[176:177], v[132:133], v[164:165], v[176:177] neg_lo:[0,1,0] neg_hi:[0,1,0]
    v_pk_fma_f32 v[180:181], v[128:129], v[164:165], v[180:181]
    buffer_load_dwordx4 a[24:27], v6, s[12:15], 0 offen offset:2048 sc1
    v_pk_fma_f32 v[178:179], v[134:135], v[166:167], v[178:179] neg_lo:[0,1,0] neg_hi:[0,1,0]
    v_pk_fma_f32 v[182:183], v[130:131], v[166:167], v[182:183]
    v_cvt_pk_bf16_f32 v140, v176, v177
    v_cvt_pk_bf16_f32 v141, v178, v179
    v_cvt_pk_bf16_f32 v142, v180, v181
    v_cvt_pk_bf16_f32 v143, v182, v183
    v_xor_b32 v48, s52, v48
    v_xor_b32 v49, s52, v49
    v_xor_b32 v52, s52, v52
    v_xor_b32 v53, s52, v53
    v_xor_b32 v54, s52, v54
    v_xor_b32 v55, s52, v55
    v_xor_b32 v58, s52, v58
    v_xor_b32 v59, s52, v59
    v_xor_b32 v60, s52, v60
    v_xor_b32 v61, s52, v61
    v_xor_b32 v64, s52, v64
    v_xor_b32 v65, s52, v65
    buffer_load_dwordx4 a[28:31], v6, s[12:15], 0 offen offset:3072 sc1
    v_add_u32 v6, 0x1000, v6
    v_xor_b32 v66, s52, v66
    v_xor_b32 v67, s52, v67
    v_xor_b32 v70, s52, v70
    v_xor_b32 v71, s52, v71
    v_mfma_f32_16x16x32_bf16 v[152:155], v[136:139], v[50:53], 0
    v_pk_mul_f32 v[240:241], v[184:185], v[216:217]
    v_pk_mul_f32 v[244:245], v[188:189], v[216:217]
    v_pk_mul_f32 v[242:243], v[186:187], v[218:219]
    v_mfma_f32_16x16x32_bf16 v[156:159], v[136:139], v[48:51], 0
    v_pk_mul_f32 v[246:247], v[190:191], v[218:219]
    v_pk_fma_f32 v[240:241], v[188:189], v[224:225], v[240:241] neg_lo:[0,1,0] neg_hi:[0,1,0]
    v_pk_fma_f32 v[244:245], v[184:185], v[224:225], v[244:245]
    v_mfma_f32_16x16x32_bf16 v[160:163], v[136:139], v[62:65], 0
    v_pk_fma_f32 v[242:243], v[190:191], v[226:227], v[242:243] neg_lo:[0,1,0] neg_hi:[0,1,0]
    v_pk_fma_f32 v[246:247], v[186:187], v[226:227], v[246:247]
    v_cvt_pk_bf16_f32 v200, v240, v241
    v_mfma_f32_16x16x32_bf16 v[164:167], v[136:139], v[60:63], 0
    v_cvt_pk_bf16_f32 v201, v242, v243
    buffer_load_dwordx4 a[32:35], v6, s[12:15], 0 offen offset:0 sc1
    v_cvt_pk_bf16_f32 v202, v244, v245
    v_cvt_pk_bf16_f32 v203, v246, v247
    v_mfma_f32_16x16x32_bf16 v[152:155], v[140:143], v[56:59], v[152:155]
    v_pk_mul_f32 v[240:241], v[192:193], v[220:221]
    v_pk_mul_f32 v[244:245], v[196:197], v[220:221]
    v_pk_mul_f32 v[242:243], v[194:195], v[222:223]
    v_mfma_f32_16x16x32_bf16 v[156:159], v[140:143], v[54:57], v[156:159]
    v_pk_mul_f32 v[246:247], v[198:199], v[222:223]
    v_pk_fma_f32 v[240:241], v[196:197], v[228:229], v[240:241] neg_lo:[0,1,0] neg_hi:[0,1,0]
    v_pk_fma_f32 v[244:245], v[192:193], v[228:229], v[244:245]
    v_mfma_f32_16x16x32_bf16 v[160:163], v[140:143], v[68:71], v[160:163]
    v_pk_fma_f32 v[242:243], v[198:199], v[230:231], v[242:243] neg_lo:[0,1,0] neg_hi:[0,1,0]
    v_pk_fma_f32 v[246:247], v[194:195], v[230:231], v[246:247]
    v_cvt_pk_bf16_f32 v204, v240, v241
    v_mfma_f32_16x16x32_bf16 v[164:167], v[140:143], v[66:69], v[164:167]
    v_cvt_pk_bf16_f32 v205, v242, v243
    v_cvt_pk_bf16_f32 v206, v244, v245
    v_cvt_pk_bf16_f32 v207, v246, v247
    buffer_load_dwordx4 a[36:39], v6, s[12:15], 0 offen offset:1024 sc1
    v_mfma_f32_16x16x32_bf16 v[216:219], v[200:203], v[50:53], 0
    v_xor_b32 v24, s52, v24
    v_xor_b32 v25, s52, v25
    v_xor_b32 v28, s52, v28
    v_mfma_f32_16x16x32_bf16 v[220:223], v[200:203], v[48:51], 0
    v_xor_b32 v29, s52, v29
    v_xor_b32 v30, s52, v30
    v_xor_b32 v31, s52, v31
    v_mfma_f32_16x16x32_bf16 v[224:227], v[200:203], v[62:65], 0
    v_xor_b32 v34, s52, v34
    v_xor_b32 v35, s52, v35
    v_pk_mul_f32 v[176:177], v[152:153], v[88:89]
    v_mfma_f32_16x16x32_bf16 v[228:231], v[200:203], v[60:63], 0
    v_pk_mul_f32 v[180:181], v[156:157], v[88:89]
    v_pk_mul_f32 v[178:179], v[154:155], v[90:91]
    v_pk_mul_f32 v[182:183], v[158:159], v[90:91]
    v_mfma_f32_16x16x32_bf16 v[216:219], v[204:207], v[56:59], v[216:219]
    v_pk_fma_f32 v[176:177], v[156:157], v[96:97], v[176:177] neg_lo:[0,1,0] neg_hi:[0,1,0]
    buffer_load_dwordx4 a[40:43], v6, s[12:15], 0 offen offset:2048 sc1
    v_pk_fma_f32 v[180:181], v[152:153], v[96:97], v[180:181]
    v_pk_fma_f32 v[178:179], v[158:159], v[98:99], v[178:179] neg_lo:[0,1,0] neg_hi:[0,1,0]
    v_mfma_f32_16x16x32_bf16 v[220:223], v[204:207], v[54:57], v[220:223]
    v_pk_fma_f32 v[182:183], v[154:155], v[98:99], v[182:183]
    v_cvt_pk_bf16_f32 v168, v176, v177
    v_cvt_pk_bf16_f32 v169, v178, v179
    v_mfma_f32_16x16x32_bf16 v[224:227], v[204:207], v[68:71], v[224:227]
    v_cvt_pk_bf16_f32 v170, v180, v181
    v_cvt_pk_bf16_f32 v171, v182, v183
    v_pk_mul_f32 v[176:177], v[160:161], v[92:93]
    v_mfma_f32_16x16x32_bf16 v[228:231], v[204:207], v[66:69], v[228:231]
    v_pk_mul_f32 v[180:181], v[164:165], v[92:93]
    v_pk_mul_f32 v[178:179], v[162:163], v[94:95]
    v_pk_mul_f32 v[182:183], v[166:167], v[94:95]
    v_pk_fma_f32 v[176:177], v[164:165], v[100:101], v[176:177] neg_lo:[0,1,0] neg_hi:[0,1,0]
    v_pk_fma_f32 v[180:181], v[160:161], v[100:101], v[180:181]
    v_pk_fma_f32 v[178:179], v[166:167], v[102:103], v[178:179] neg_lo:[0,1,0] neg_hi:[0,1,0]
    v_pk_fma_f32 v[182:183], v[162:163], v[102:103], v[182:183]
    buffer_load_dwordx4 a[44:47], v6, s[12:15], 0 offen offset:3072 sc1
    v_add_u32 v6, 0x1000, v6
    v_cvt_pk_bf16_f32 v172, v176, v177
    v_cvt_pk_bf16_f32 v173, v178, v179
    v_cvt_pk_bf16_f32 v174, v180, v181
    v_cvt_pk_bf16_f32 v175, v182, v183
    ds_write_b128 v14, v[168:171] offset:16384
    ds_write_b128 v14, v[172:175] offset:17408
    v_pk_mul_f32 v[240:241], v[216:217], v[88:89]
    v_pk_mul_f32 v[244:245], v[220:221], v[88:89]
    v_pk_mul_f32 v[242:243], v[218:219], v[90:91]
    v_pk_mul_f32 v[246:247], v[222:223], v[90:91]
    v_pk_fma_f32 v[240:241], v[220:221], v[96:97], v[240:241] neg_lo:[0,1,0] neg_hi:[0,1,0]
    v_pk_fma_f32 v[244:245], v[216:217], v[96:97], v[244:245]
    v_pk_fma_f32 v[242:243], v[222:223], v[98:99], v[242:243] neg_lo:[0,1,0] neg_hi:[0,1,0]
    v_pk_fma_f32 v[246:247], v[218:219], v[98:99], v[246:247]
    v_cvt_pk_bf16_f32 v232, v240, v241
    v_cvt_pk_bf16_f32 v233, v242, v243
    v_cvt_pk_bf16_f32 v234, v244, v245
    v_cvt_pk_bf16_f32 v235, v246, v247
    buffer_load_dwordx4 a[48:51], v6, s[12:15], 0 offen offset:0 sc1
    v_pk_mul_f32 v[240:241], v[224:225], v[92:93]
    v_pk_mul_f32 v[244:245], v[228:229], v[92:93]
    v_pk_mul_f32 v[242:243], v[226:227], v[94:95]
    v_pk_mul_f32 v[246:247], v[230:231], v[94:95]
    v_pk_fma_f32 v[240:241], v[228:229], v[100:101], v[240:241] neg_lo:[0,1,0] neg_hi:[0,1,0]
    v_pk_fma_f32 v[244:245], v[224:225], v[100:101], v[244:245]
    v_pk_fma_f32 v[242:243], v[230:231], v[102:103], v[242:243] neg_lo:[0,1,0] neg_hi:[0,1,0]
    v_pk_fma_f32 v[246:247], v[226:227], v[102:103], v[246:247]
    v_cvt_pk_bf16_f32 v236, v240, v241
    v_cvt_pk_bf16_f32 v237, v242, v243
    v_cvt_pk_bf16_f32 v238, v244, v245
    v_cvt_pk_bf16_f32 v239, v246, v247
    ds_write_b128 v14, v[232:235] offset:24608
    ds_write_b128 v14, v[236:239] offset:25632
    v_xor_b32 v36, s52, v36
    v_xor_b32 v37, s52, v37
    v_xor_b32 v40, s52, v40
    v_xor_b32 v41, s52, v41
    buffer_load_dwordx4 a[52:55], v6, s[12:15], 0 offen offset:1024 sc1
    v_xor_b32 v42, s52, v42
    v_xor_b32 v43, s52, v43
    v_xor_b32 v46, s52, v46
    v_xor_b32 v47, s52, v47
    s_waitcnt vmcnt(14)
    s_waitcnt lgkmcnt(0)
    s_barrier
    ds_read_b128 v[120:123], v13 offset:16384
    ds_read_b128 v[128:131], v13 offset:18432
    ds_read_b128 v[136:139], v13 offset:20480
    ds_read_b128 v[144:147], v13 offset:22528
    ds_read_b128 v[124:127], v13 offset:17408
    ds_read_b128 v[132:135], v13 offset:19456
    ds_read_b128 v[140:143], v13 offset:21504
    ds_read_b128 v[148:151], v13 offset:23552
    s_waitcnt lgkmcnt(7)
    v_mfma_f32_16x16x32_bf16 v[152:155], v[26:29], v[120:123], 0
    ds_read_b128 v[184:187], v13 offset:16416
    v_mfma_f32_16x16x32_bf16 v[156:159], v[24:27], v[120:123], 0
    ds_read_b128 v[192:195], v13 offset:18464
    s_waitcnt lgkmcnt(8)
    v_mfma_f32_16x16x32_bf16 v[152:155], v[32:35], v[128:131], v[152:155]
    buffer_load_dwordx4 a[56:59], v6, s[12:15], 0 offen offset:2048 sc1
    ds_read_b128 v[200:203], v13 offset:20512
    v_mfma_f32_16x16x32_bf16 v[156:159], v[30:33], v[128:131], v[156:159]
    ds_read_b128 v[208:211], v13 offset:22560
    s_waitcnt lgkmcnt(9)
    v_mfma_f32_16x16x32_bf16 v[152:155], v[38:41], v[136:139], v[152:155]
    ds_read_b128 v[188:191], v13 offset:17440
    v_mfma_f32_16x16x32_bf16 v[156:159], v[36:39], v[136:139], v[156:159]
    ds_read_b128 v[196:199], v13 offset:19488
    s_waitcnt lgkmcnt(10)
    v_mfma_f32_16x16x32_bf16 v[152:155], v[44:47], v[144:147], v[152:155]
    ds_read_b128 v[204:207], v13 offset:21536
    v_mfma_f32_16x16x32_bf16 v[156:159], v[42:45], v[144:147], v[156:159]
    ds_read_b128 v[212:215], v13 offset:23584
    s_waitcnt lgkmcnt(11)
    v_mfma_f32_16x16x32_bf16 v[160:163], v[26:29], v[124:127], 0
    v_mfma_f32_16x16x32_bf16 v[164:167], v[24:27], v[124:127], 0
    s_waitcnt lgkmcnt(10)
    v_mfma_f32_16x16x32_bf16 v[160:163], v[32:35], v[132:135], v[160:163]
    v_mfma_f32_16x16x32_bf16 v[164:167], v[30:33], v[132:135], v[164:167]
    s_waitcnt lgkmcnt(9)
    v_mfma_f32_16x16x32_bf16 v[160:163], v[38:41], v[140:143], v[160:163]
    v_mfma_f32_16x16x32_bf16 v[164:167], v[36:39], v[140:143], v[164:167]
    s_waitcnt lgkmcnt(8)
    v_mfma_f32_16x16x32_bf16 v[160:163], v[44:47], v[148:151], v[160:163]
    buffer_load_dwordx4 a[60:63], v6, s[12:15], 0 offen offset:3072 sc1
    v_add_u32 v6, 0x1000, v6
    v_mfma_f32_16x16x32_bf16 v[164:167], v[42:45], v[148:151], v[164:167]
    s_waitcnt lgkmcnt(7)
    v_mfma_f32_16x16x32_bf16 v[216:219], v[26:29], v[184:187], 0
    v_fma_f32 v176, -v157, v18, v152
    v_fma_f32 v177, v156, v18, v153
    v_mfma_f32_16x16x32_bf16 v[220:223], v[24:27], v[184:187], 0
    v_fma_f32 v178, v157, v18, v152
    v_fma_f32 v179, -v156, v18, v153
    s_waitcnt lgkmcnt(6)
    v_mfma_f32_16x16x32_bf16 v[216:219], v[32:35], v[192:195], v[216:219]
    v_fma_f32 v180, -v159, v18, v154
    v_fma_f32 v181, v158, v18, v155
    v_mfma_f32_16x16x32_bf16 v[220:223], v[30:33], v[192:195], v[220:223]
    v_fma_f32 v182, v159, v18, v154
    v_fma_f32 v183, -v158, v18, v155
    s_waitcnt lgkmcnt(5)
    v_mfma_f32_16x16x32_bf16 v[216:219], v[38:41], v[200:203], v[216:219]
    v_cvt_pk_bf16_f32 v168, v176, v177
    v_cvt_pk_bf16_f32 v169, v178, v179
    v_mfma_f32_16x16x32_bf16 v[220:223], v[36:39], v[200:203], v[220:223]
    v_cvt_pk_bf16_f32 v170, v180, v181
    v_cvt_pk_bf16_f32 v171, v182, v183
    s_waitcnt lgkmcnt(4)
    v_mfma_f32_16x16x32_bf16 v[216:219], v[44:47], v[208:211], v[216:219]
    v_or_b32 v168, 1, v168
    buffer_store_dwordx4 v[168:171], v5, s[16:19], s53 offen offset:0 sc1
    v_mfma_f32_16x16x32_bf16 v[220:223], v[42:45], v[208:211], v[220:223]
    v_fma_f32 v176, -v165, v18, v160
    v_fma_f32 v177, v164, v18, v161
    s_waitcnt lgkmcnt(3)
    v_mfma_f32_16x16x32_bf16 v[224:227], v[26:29], v[188:191], 0
    v_fma_f32 v178, v165, v18, v160
    v_fma_f32 v179, -v164, v18, v161
    v_mfma_f32_16x16x32_bf16 v[228:231], v[24:27], v[188:191], 0
    v_fma_f32 v180, -v167, v18, v162
    v_fma_f32 v181, v166, v18, v163
    s_waitcnt lgkmcnt(2)
    v_mfma_f32_16x16x32_bf16 v[224:227], v[32:35], v[196:199], v[224:227]
    v_fma_f32 v182, v167, v18, v162
    v_fma_f32 v183, -v166, v18, v163
    v_mfma_f32_16x16x32_bf16 v[228:231], v[30:33], v[196:199], v[228:231]
    v_cvt_pk_bf16_f32 v172, v176, v177
    v_cvt_pk_bf16_f32 v173, v178, v179
    s_waitcnt lgkmcnt(1)
    v_mfma_f32_16x16x32_bf16 v[224:227], v[38:41], v[204:207], v[224:227]
    v_cvt_pk_bf16_f32 v174, v180, v181
    v_cvt_pk_bf16_f32 v175, v182, v183
    v_mfma_f32_16x16x32_bf16 v[228:231], v[36:39], v[204:207], v[228:231]
    v_or_b32 v172, 1, v172
    buffer_store_dwordx4 v[172:175], v5, s[16:19], s53 offen offset:2048 sc1
    s_waitcnt lgkmcnt(0)
    v_mfma_f32_16x16x32_bf16 v[224:227], v[44:47], v[212:215], v[224:227]
    v_mfma_f32_16x16x32_bf16 v[228:231], v[42:45], v[212:215], v[228:231]
    v_fma_f32 v240, -v221, v18, v216
    v_fma_f32 v241, v220, v18, v217
    v_fma_f32 v242, v221, v18, v216
    v_fma_f32 v243, -v220, v18, v217
    v_fma_f32 v244, -v223, v18, v218
    v_fma_f32 v245, v222, v18, v219
    v_fma_f32 v246, v223, v18, v218
    v_fma_f32 v247, -v222, v18, v219
    v_cvt_pk_bf16_f32 v232, v240, v241
    v_cvt_pk_bf16_f32 v233, v242, v243
    v_cvt_pk_bf16_f32 v234, v244, v245
    v_cvt_pk_bf16_f32 v235, v246, v247
    v_or_b32 v232, 1, v232
    buffer_store_dwordx4 v[232:235], v5, s[16:19], s53 offen offset:1024 sc1
    v_fma_f32 v240, -v229, v18, v224
    v_fma_f32 v241, v228, v18, v225
    v_fma_f32 v242, v229, v18, v224
    v_fma_f32 v243, -v228, v18, v225
    v_fma_f32 v244, -v231, v18, v226
    v_fma_f32 v245, v230, v18, v227
    v_fma_f32 v246, v231, v18, v226
    v_fma_f32 v247, -v230, v18, v227
    v_cvt_pk_bf16_f32 v236, v240, v241
    v_cvt_pk_bf16_f32 v237, v242, v243
    v_cvt_pk_bf16_f32 v238, v244, v245
    v_cvt_pk_bf16_f32 v239, v246, v247
    v_or_b32 v236, 1, v236
    buffer_store_dwordx4 v[236:239], v5, s[16:19], s53 offen offset:3072 sc1
    buffer_load_dwordx4 a[64:67], v6, s[12:15], 0 offen offset:0 sc1
    buffer_load_dwordx4 a[68:71], v6, s[12:15], 0 offen offset:1024 sc1
    buffer_load_dwordx4 a[72:75], v6, s[12:15], 0 offen offset:2048 sc1
    buffer_load_dwordx4 a[76:79], v6, s[12:15], 0 offen offset:3072 sc1
    v_add_u32 v6, 0x1000, v6
    buffer_load_dwordx4 a[80:83], v6, s[12:15], 0 offen offset:0 sc1
    buffer_load_dwordx4 a[84:87], v6, s[12:15], 0 offen offset:1024 sc1
    buffer_load_dwordx4 a[88:91], v6, s[12:15], 0 offen offset:2048 sc1
    buffer_load_dwordx4 a[92:95], v6, s[12:15], 0 offen offset:3072 sc1
    v_add_u32 v6, 0x1000, v6
    v_lshrrev_b32 v12, 2, v0
    v_lshlrev_b32 v12, 14, v12
    v_and_b32 v85, 3, v0
    v_lshl_add_u32 v12, v85, 4, v12
    v_lshrrev_b32 v85, 1, v0
    v_cmp_ge_u32 s[34:35], 64, v85
    v_mov_b32 v32, -1
    v_add_u32 v93, s88, v5
    v_mov_b32 v2, 0
    v_mov_b32 v3, 1
    v_lshrrev_b32 v90, 1, v8
    v_mad_u32_u24 v89, v7, 5, v90
    v_and_b32 v88, 1, v8
    v_mul_u32_u24 v9, 49152, v88
    v_lshlrev_b32 v10, 2, v9
    buffer_load_dwordx4 a[96:99], v6, s[12:15], 0 offen offset:0 sc1
    v_lshl_add_u32 v9, v90, 8, v9
    v_lshl_add_u32 v9, v7, 4, v9
    v_mul_u32_u24 v90, 49152, v90
    v_add_u32 v10, v10, v90
    v_lshl_add_u32 v10, v7, 4, v10
    v_lshl_add_u32 v88, v1, 1, v88
    buffer_load_dwordx4 a[100:103], v6, s[12:15], 0 offen offset:1024 sc1
    v_add_u32 v90, 0, v89
    v_xor_b32 v18, v90, v88
    v_and_b32 v18, 7, v18
    v_lshl_add_u32 v18, v90, 3, v18
    v_lshlrev_b32 v18, 4, v18
    v_add_u32 v18, 122880, v18
    buffer_load_dwordx4 a[104:107], v6, s[12:15], 0 offen offset:2048 sc1
    v_add_u32 v90, 2, v89
    v_xor_b32 v19, v90, v88
    v_and_b32 v19, 7, v19
    v_lshl_add_u32 v19, v90, 3, v19
    v_lshlrev_b32 v19, 4, v19
    v_add_u32 v19, 122880, v19
    buffer_load_dwordx4 a[108:111], v6, s[12:15], 0 offen offset:3072 sc1
    v_add_u32 v6, 0x1000, v6
    v_add_u32 v90, 4, v89
    v_xor_b32 v20, v90, v88
    v_and_b32 v20, 7, v20
    v_lshl_add_u32 v20, v90, 3, v20
    v_lshlrev_b32 v20, 4, v20
    v_add_u32 v20, 122880, v20
    buffer_load_dwordx4 a[112:115], v6, s[12:15], 0 offen offset:0 sc1
    v_mul_u32_u24 v21, 1280, v88
    v_lshl_add_u32 v21, v89, 4, v21
    v_add_u32 v21, 122880, v21
    v_lshrrev_b32 v90, 3, v0
    v_xor_b32 v22, v90, v0
    v_and_b32 v22, 7, v22
    buffer_load_dwordx4 a[116:119], v6, s[12:15], 0 offen offset:1024 sc1
    v_add_u32 v6, 1937408, v6
    v_lshlrev_b32 v22, 4, v22
    v_lshl_add_u32 v22, v90, 8, v22
    v_and_b32 v84, 1, v0
    v_mul_u32_u24 v13, 5184, v84
    v_sub_u32 v14, 384, v85
    v_lshl_add_u32 v14, v14, 2, v13
    buffer_load_dwordx4 a[120:123], v6, s[12:15], 0 offen offset:0 sc1
    v_lshl_add_u32 v13, v85, 2, v13
    s_mul_i32 s24, s22, 2592
    v_lshl_add_u32 v15, v4, 2, s24
    v_mov_b32 v142, 0
    v_mov_b32 v143, 0
    v_mul_u32_u24 v16, 80, v7
    buffer_load_dwordx4 a[124:127], v6, s[12:15], 0 offen offset:1024 sc1
    v_lshl_add_u32 v16, v8, 3, v16
    v_lshlrev_b32 v17, 1, v16
    v_add_u32 v16, s30, v16
    v_mov_b32 v44, 0
    v_mov_b32 v45, 0
    v_mov_b32 v46, 0
    v_mov_b32 v47, 0
    s_nop 0
LJOIN:
    s_mov_b32 m0, s88
    s_nop 0
    buffer_load_dwordx4 v5, s[12:15], s31 offen sc1 lds
    buffer_load_dwordx4 v5, s[12:15], s31 offen offset:1024 sc1 lds
    buffer_load_dwordx4 v[24:27], v12, s[16:19], s25 offen sc1
    buffer_load_dwordx4 v[28:31], v12, s[16:19], s26 offen sc1
    s_mov_b64 exec, s[34:35]
    buffer_load_dwordx4 v[32:35], v12, s[16:19], s27 offen sc1
    s_mov_b64 exec, -1
    v_add_u32 v23, 51200, v5
    s_mov_b32 s50, 0
    ds_read_b64 v[36:37], v16 offset:0
    ds_read_b64 v[38:39], v16 offset:1280
    ds_read_b64 v[40:41], v16 offset:32
    ds_read_b64 v[42:43], v16 offset:1312
    s_mov_b32 exec_hi, 0
    ds_read_b64 v[44:45], v16 offset:64
    ds_read_b64 v[46:47], v16 offset:1344
    s_mov_b64 exec, -1
    ds_read_b128 v[152:155], v23 offset:0
    ds_read_b128 v[156:159], v23 offset:1024
    ds_read_b128 v[160:163], v23 offset:2048
    ds_read_b128 v[164:167], v23 offset:3072
    ds_read_b128 v[168:171], v23 offset:4096
    ds_read_b128 v[172:175], v23 offset:5120
    ds_read_b128 v[176:179], v23 offset:6144
    ds_read_b128 v[180:183], v23 offset:7168
    s_waitcnt lgkmcnt(13)
    v_lshlrev_b32 v108, 16, v36
    v_and_b32 v109, 0xffff0000, v36
    ds_read_b128 v[184:187], v23 offset:8192
    v_lshlrev_b32 v110, 16, v37
    v_and_b32 v111, 0xffff0000, v37
    ds_read_b128 v[188:191], v23 offset:9216
    s_waitcnt lgkmcnt(14)
    v_lshlrev_b32 v112, 16, v38
    v_and_b32 v113, 0xffff0000, v38
    ds_read_b128 v[192:195], v23 offset:10240
    v_lshlrev_b32 v114, 16, v39
    v_and_b32 v115, 0xffff0000, v39
    ds_read_b128 v[196:199], v23 offset:11264
    s_waitcnt lgkmcnt(15)
    v_lshlrev_b32 v116, 16, v40
    v_and_b32 v117, 0xffff0000, v40
    ds_read_b128 v[200:203], v23 offset:12288
    v_lshlrev_b32 v118, 16, v41
    v_and_b32 v119, 0xffff0000, v41
    ds_read_b128 v[204:207], v23 offset:13312
    s_waitcnt lgkmcnt(15)
    v_lshlrev_b32 v120, 16, v42
    v_and_b32 v121, 0xffff0000, v42
    ds_read_b128 v[208:211], v23 offset:14336
    v_lshlrev_b32 v122, 16, v43
    v_and_b32 v123, 0xffff0000, v43
    ds_read_b128 v[212:215], v23 offset:15360
    v_lshlrev_b32 v124, 16, v44
    v_and_b32 v125, 0xffff0000, v44
    ds_read_b128 v[216:219], v23 offset:16384
    v_lshlrev_b32 v126, 16, v45
    v_and_b32 v127, 0xffff0000, v45
    ds_read_b128 v[220:223], v23 offset:17408
    s_waitcnt lgkmcnt(15)
    v_lshlrev_b32 v128, 16, v46
    v_and_b32 v129, 0xffff0000, v46
    ds_read_b128 v[224:227], v23 offset:18432
    v_lshlrev_b32 v130, 16, v47
    v_and_b32 v131, 0xffff0000, v47
    ds_read_b128 v[228:231], v23 offset:19456
    ds_read_b128 v[232:235], v23 offset:20480
    ds_read_b128 v[236:239], v23 offset:21504
    ds_read_b128 v[240:243], v23 offset:22528
    s_mov_b32 s98, 0x80000000
    s_mov_b32 s99, 0x00008000
    v_xor_b32 v152, s98, v152
    v_xor_b32 v153, s98, v153
    v_xor_b32 v154, s98, v154
    v_xor_b32 v155, s98, v155
    v_xor_b32 v156, s98, v156
    v_xor_b32 v157, s98, v157
    v_xor_b32 v158, s98, v158
    v_xor_b32 v159, s98, v159
    v_xor_b32 v160, s98, v160
    v_xor_b32 v161, s98, v161
    v_xor_b32 v162, s99, v162
    v_xor_b32 v163, s99, v163
    s_waitcnt lgkmcnt(15)
    v_xor_b32 v164, s99, v164
    v_xor_b32 v165, s99, v165
    v_xor_b32 v166, s99, v166
    v_xor_b32 v167, s99, v167
    v_xor_b32 v168, s99, v168
    v_xor_b32 v169, s99, v169
    v_xor_b32 v170, s99, v170
    v_xor_b32 v171, s99, v171
    v_xor_b32 v172, s98, v172
    v_xor_b32 v173, s98, v173
    v_xor_b32 v174, s98, v174
    v_xor_b32 v175, s98, v175
    v_xor_b32 v176, s98, v176
    v_xor_b32 v177, s98, v177
    v_xor_b32 v178, s98, v178
    v_xor_b32 v179, s98, v179
    v_xor_b32 v180, s98, v180
    v_xor_b32 v181, s98, v181
    v_xor_b32 v182, s99, v182
    v_xor_b32 v183, s99, v183
    s_waitcnt lgkmcnt(14)
    v_xor_b32 v184, s99, v184
    v_xor_b32 v185, s99, v185
    v_xor_b32 v186, s99, v186
    v_xor_b32 v187, s99, v187
    s_waitcnt lgkmcnt(13)
    v_xor_b32 v188, s99, v188
    v_xor_b32 v189, s99, v189
    v_xor_b32 v190, s99, v190
    v_xor_b32 v191, s99, v191
    s_waitcnt lgkmcnt(12)
    v_xor_b32 v192, s98, v192
    v_xor_b32 v193, s98, v193
    v_xor_b32 v194, s98, v194
    v_xor_b32 v195, s98, v195
    s_waitcnt lgkmcnt(11)
    v_xor_b32 v196, s98, v196
    v_xor_b32 v197, s98, v197
    v_xor_b32 v198, s98, v198
    v_xor_b32 v199, s98, v199
    s_waitcnt lgkmcnt(10)
    v_xor_b32 v200, s98, v200
    v_xor_b32 v201, s98, v201
    v_xor_b32 v202, s99, v202
    v_xor_b32 v203, s99, v203
    s_waitcnt lgkmcnt(9)
    v_xor_b32 v204, s99, v204
    v_xor_b32 v205, s99, v205
    v_xor_b32 v206, s99, v206
    v_xor_b32 v207, s99, v207
    s_waitcnt lgkmcnt(8)
    v_xor_b32 v208, s99, v208
    v_xor_b32 v209, s99, v209
    v_xor_b32 v210, s99, v210
    v_xor_b32 v211, s99, v211
    s_waitcnt vmcnt(1)
    v_and_b32 v90, v24, v28
    ds_read2st64_b32 v[94:95], v93 offset0:0 offset1:4
    s_waitcnt vmcnt(0)
    v_and_b32 v90, v90, v32
    v_and_b32 v90, 1, v90
    v_add_u32 v90, -1, v90
    s_waitcnt lgkmcnt(0)
    v_max3_u32 v90, v90, v94, v95
    v_cmp_eq_u32 s[62:63], -1, v90
    s_nop 0
    s_cmp_lg_u64 s[62:63], 0
    s_nop 1
    s_cbranch_scc1 LY_slow
LY_ok:
    ds_write_b32 v13, v24 offset:0
    ds_write_b32 v14, v25 offset:1024
    ds_write_b32 v13, v26 offset:2592
    ds_write_b32 v14, v27 offset:3616
    ds_write_b32 v13, v28 offset:512
    ds_write_b32 v14, v29 offset:512
    ds_write_b32 v13, v30 offset:3104
    ds_write_b32 v14, v31 offset:3104
    s_mov_b64 exec, s[34:35]
    ds_write_b32 v13, v32 offset:1024
    ds_write_b32 v14, v33 offset:0
    ds_write_b32 v13, v34 offset:3616
    ds_write_b32 v14, v35 offset:2592
    s_mov_b64 exec, -1
    v_lshlrev_b32 v12, 4, v0
    v_add_u32 v12, 122880, v12
    s_waitcnt lgkmcnt(0)
    s_barrier
    ds_read2st64_b32 v[132:133], v15 offset0:0 offset1:1
    ds_read2st64_b32 v[134:135], v15 offset0:2 offset1:3
    ds_read2st64_b32 v[136:137], v15 offset0:4 offset1:5
    ds_read2st64_b32 v[138:139], v15 offset0:6 offset1:7
    ds_read2st64_b32 v[140:141], v15 offset0:8 offset1:9
    s_waitcnt lgkmcnt(3)
    v_mfma_f32_16x16x32_bf16 v[84:87], v[132:135], v[152:155], 0
    v_mfma_f32_16x16x32_bf16 v[88:91], v[132:135], v[162:165], 0
    s_waitcnt lgkmcnt(1)
    v_mfma_f32_16x16x32_bf16 v[84:87], v[136:139], v[156:159], v[84:87]
    v_mfma_f32_16x16x32_bf16 v[88:91], v[136:139], v[166:169], v[88:91]
    s_waitcnt lgkmcnt(0)
    v_mfma_f32_16x16x32_bf16 v[84:87], v[140:143], v[160:163], v[84:87]
    v_mfma_f32_16x16x32_bf16 v[88:91], v[140:143], v[170:173], v[88:91]
    v_mfma_f32_16x16x32_bf16 v[92:95], v[132:135], v[172:175], 0
    ds_read_b128 v[48:51], v17 offset:43008
    ds_read_b128 v[52:55], v17 offset:43072
    v_mfma_f32_16x16x32_bf16 v[96:99], v[132:135], v[182:185], 0
    ds_read_b128 v[56:59], v17 offset:43136
    ds_read_b128 v[72:75], v17 offset:45568
    buffer_load_dwordx4 a[128:131], v6, s[12:15], 0 offen offset:2048 sc1
    v_mfma_f32_16x16x32_bf16 v[92:95], v[136:139], v[176:179], v[92:95]
    ds_read_b128 v[76:79], v17 offset:45632
    ds_read_b128 v[80:83], v17 offset:45696
    v_mfma_f32_16x16x32_bf16 v[96:99], v[136:139], v[186:189], v[96:99]
    ds_read_b128 v[60:63], v17 offset:48128
    ds_read_b128 v[64:67], v17 offset:48192
    v_mfma_f32_16x16x32_bf16 v[92:95], v[140:143], v[180:183], v[92:95]
    ds_read_b128 v[68:71], v17 offset:48256
    v_mfma_f32_16x16x32_bf16 v[96:99], v[140:143], v[190:193], v[96:99]
    v_mfma_f32_16x16x32_bf16 v[100:103], v[132:135], v[192:195], 0
    v_mfma_f32_16x16x32_bf16 v[104:107], v[132:135], v[202:205], 0
    v_mfma_f32_16x16x32_bf16 v[100:103], v[136:139], v[196:199], v[100:103]
    buffer_load_dwordx4 a[132:135], v6, s[12:15], 0 offen offset:3072 sc1
    v_add_u32 v6, 0x1000, v6
    v_mfma_f32_16x16x32_bf16 v[104:107], v[136:139], v[206:209], v[104:107]
    v_mfma_f32_16x16x32_bf16 v[100:103], v[140:143], v[200:203], v[100:103]
    v_mfma_f32_16x16x32_bf16 v[104:107], v[140:143], v[210:213], v[104:107]
    v_pk_mul_f32 v[144:145], v[84:85], v[220:221]
    v_pk_mul_f32 v[148:149], v[88:89], v[220:221]
    v_pk_mul_f32 v[146:147], v[86:87], v[222:223]
    v_pk_mul_f32 v[150:151], v[90:91], v[222:223]
    v_pk_fma_f32 v[144:145], v[88:89], v[232:233], v[144:145] neg_lo:[0,1,0] neg_hi:[0,1,0]
    v_pk_fma_f32 v[148:149], v[84:85], v[232:233], v[148:149]
    v_pk_fma_f32 v[146:147], v[90:91], v[234:235], v[146:147] neg_lo:[0,1,0] neg_hi:[0,1,0]
    v_pk_fma_f32 v[150:151], v[86:87], v[234:235], v[150:151]
    v_cvt_pk_bf16_f32 v24, v144, v145
    buffer_load_dwordx4 a[136:139], v6, s[12:15], 0 offen offset:0 sc1
    v_cvt_pk_bf16_f32 v25, v146, v147
    v_cvt_pk_bf16_f32 v26, v148, v149
    v_cvt_pk_bf16_f32 v27, v150, v151
    s_nop 1
    v_mfma_f32_16x16x32_bf16 v[152:155], v[24:27], v[216:219], 0
    v_mfma_f32_16x16x32_bf16 v[156:159], v[24:27], v[214:217], 0
    v_pk_mul_f32 v[144:145], v[92:93], v[224:225]
    v_pk_mul_f32 v[148:149], v[96:97], v[224:225]
    v_pk_mul_f32 v[146:147], v[94:95], v[226:227]
    v_pk_mul_f32 v[150:151], v[98:99], v[226:227]
    v_pk_fma_f32 v[144:145], v[96:97], v[236:237], v[144:145] neg_lo:[0,1,0] neg_hi:[0,1,0]
    v_pk_fma_f32 v[148:149], v[92:93], v[236:237], v[148:149]
    v_pk_fma_f32 v[146:147], v[98:99], v[238:239], v[146:147] neg_lo:[0,1,0] neg_hi:[0,1,0]
    buffer_load_dwordx4 a[140:143], v6, s[12:15], 0 offen offset:1024 sc1
    v_pk_fma_f32 v[150:151], v[94:95], v[238:239], v[150:151]
    v_cvt_pk_bf16_f32 v28, v144, v145
    v_cvt_pk_bf16_f32 v29, v146, v147
    v_cvt_pk_bf16_f32 v30, v148, v149
    v_cvt_pk_bf16_f32 v31, v150, v151
    s_nop 1
    v_mfma_f32_16x16x32_bf16 v[160:163], v[28:31], v[216:219], 0
    v_mfma_f32_16x16x32_bf16 v[164:167], v[28:31], v[214:217], 0
    v_pk_mul_f32 v[144:145], v[100:101], v[228:229]
    v_pk_mul_f32 v[148:149], v[104:105], v[228:229]
    v_pk_mul_f32 v[146:147], v[102:103], v[230:231]
    v_pk_mul_f32 v[150:151], v[106:107], v[230:231]
    v_pk_fma_f32 v[144:145], v[104:105], v[240:241], v[144:145] neg_lo:[0,1,0] neg_hi:[0,1,0]
    buffer_load_dwordx4 a[144:147], v6, s[12:15], 0 offen offset:2048 sc1
    v_pk_fma_f32 v[148:149], v[100:101], v[240:241], v[148:149]
    v_pk_fma_f32 v[146:147], v[106:107], v[242:243], v[146:147] neg_lo:[0,1,0] neg_hi:[0,1,0]
    v_pk_fma_f32 v[150:151], v[102:103], v[242:243], v[150:151]
    v_cvt_pk_bf16_f32 v32, v144, v145
    v_cvt_pk_bf16_f32 v33, v146, v147
    v_cvt_pk_bf16_f32 v34, v148, v149
    v_cvt_pk_bf16_f32 v35, v150, v151
    s_nop 1
    v_mfma_f32_16x16x32_bf16 v[168:171], v[32:35], v[216:219], 0
    v_mfma_f32_16x16x32_bf16 v[172:175], v[32:35], v[214:217], 0
    s_waitcnt lgkmcnt(8)
    v_pk_fma_f32 v[108:109], v[152:153], v[48:49], v[108:109]
    v_pk_fma_f32 v[110:111], v[154:155], v[50:51], v[110:111]
    v_pk_fma_f32 v[112:113], v[156:157], v[48:49], v[112:113]
    buffer_load_dwordx4 a[148:151], v6, s[12:15], 0 offen offset:3072 sc1
    v_add_u32 v6, 0x1000, v6
    v_pk_fma_f32 v[114:115], v[158:159], v[50:51], v[114:115]
    v_pk_add_f32 v[176:177], v[108:109], v[110:111]
    v_pk_mul_f32 v[180:181], v[108:109], v[108:109]
    v_pk_add_f32 v[178:179], v[112:113], v[114:115]
    v_pk_mul_f32 v[182:183], v[112:113], v[112:113]
    v_pk_fma_f32 v[180:181], v[110:111], v[110:111], v[180:181]
    v_pk_fma_f32 v[182:183], v[114:115], v[114:115], v[182:183]
    s_waitcnt lgkmcnt(7)
    v_pk_fma_f32 v[116:117], v[160:161], v[52:53], v[116:117]
    v_pk_fma_f32 v[118:119], v[162:163], v[54:55], v[118:119]
    v_pk_fma_f32 v[120:121], v[164:165], v[52:53], v[120:121]
    v_pk_fma_f32 v[122:123], v[166:167], v[54:55], v[122:123]
    v_pk_add_f32 v[176:177], v[176:177], v[116:117]
    buffer_load_dwordx4 a[152:155], v6, s[12:15], 0 offen offset:0 sc1
    v_pk_fma_f32 v[180:181], v[116:117], v[116:117], v[180:181]
    v_pk_add_f32 v[178:179], v[178:179], v[120:121]
    v_pk_fma_f32 v[182:183], v[120:121], v[120:121], v[182:183]
    v_pk_add_f32 v[176:177], v[176:177], v[118:119]
    v_pk_fma_f32 v[180:181], v[118:119], v[118:119], v[180:181]
    v_pk_add_f32 v[178:179], v[178:179], v[122:123]
    v_pk_fma_f32 v[182:183], v[122:123], v[122:123], v[182:183]
    s_waitcnt lgkmcnt(6)
    v_pk_fma_f32 v[124:125], v[168:169], v[56:57], v[124:125]
    v_pk_fma_f32 v[126:127], v[170:171], v[58:59], v[126:127]
    v_pk_fma_f32 v[128:129], v[172:173], v[56:57], v[128:129]
    v_pk_fma_f32 v[130:131], v[174:175], v[58:59], v[130:131]
    v_pk_add_f32 v[176:177], v[176:177], v[124:125]
    buffer_load_dwordx4 a[156:159], v6, s[12:15], 0 offen offset:1024 sc1
    v_pk_fma_f32 v[180:181], v[124:125], v[124:125], v[180:181]
    v_pk_add_f32 v[178:179], v[178:179], v[128:129]
    v_pk_fma_f32 v[182:183], v[128:129], v[128:129], v[182:183]
    v_pk_add_f32 v[176:177], v[176:177], v[126:127]
    v_pk_fma_f32 v[180:181], v[126:127], v[126:127], v[180:181]
    v_pk_add_f32 v[178:179], v[178:179], v[130:131]
    v_pk_fma_f32 v[182:183], v[130:131], v[130:131], v[182:183]
    v_add_f32 v176, v176, v177
    v_add_f32 v178, v178, v179
    v_add_f32 v180, v180, v181
    v_add_f32 v182, v182, v183
    v_add_f32_dpp v176, v176, v176 quad_perm:[1,0,3,2] row_mask:0xf bank_mask:0xf
    buffer_load_dwordx4 a[160:163], v6, s[12:15], 0 offen offset:2048 sc1
    v_add_f32_dpp v178, v178, v178 quad_perm:[1,0,3,2] row_mask:0xf bank_mask:0xf
    v_add_f32_dpp v180, v180, v180 quad_perm:[1,0,3,2] row_mask:0xf bank_mask:0xf
    v_add_f32_dpp v182, v182, v182 quad_perm:[1,0,3,2] row_mask:0xf bank_mask:0xf
    v_add_f32_dpp v176, v176, v176 quad_perm:[2,3,0,1] row_mask:0xf bank_mask:0xf
    v_add_f32_dpp v178, v178, v178 quad_perm:[2,3,0,1] row_mask:0xf bank_mask:0xf
    v_add_f32_dpp v180, v180, v180 quad_perm:[2,3,0,1] row_mask:0xf bank_mask:0xf
    v_add_f32_dpp v182, v182, v182 quad_perm:[2,3,0,1] row_mask:0xf bank_mask:0xf
    v_add_f32_dpp v176, v176, v176 row_half_mirror row_mask:0xf bank_mask:0xf
    v_add_f32_dpp v178, v178, v178 row_half_mirror row_mask:0xf bank_mask:0xf
    v_add_f32_dpp v180, v180, v180 row_half_mirror row_mask:0xf bank_mask:0xf
    v_add_f32_dpp v182, v182, v182 row_half_mirror row_mask:0xf bank_mask:0xf
    v_add_f32_dpp v176, v176, v176 row_mirror row_mask:0xf bank_mask:0xf
    buffer_load_dwordx4 a[164:167], v6, s[12:15], 0 offen offset:3072 sc1
    v_add_u32 v6, 0x1000, v6
    v_add_f32_dpp v178, v178, v178 row_mirror row_mask:0xf bank_mask:0xf
    v_add_f32_dpp v180, v180, v180 row_mirror row_mask:0xf bank_mask:0xf
    v_add_f32_dpp v182, v182, v182 row_mirror row_mask:0xf bank_mask:0xf
    v_add_f32_dpp v176, v176, v176 row_bcast:15 row_mask:0xa bank_mask:0xf
    v_add_f32_dpp v178, v178, v178 row_bcast:15 row_mask:0xa bank_mask:0xf
    v_add_f32_dpp v180, v180, v180 row_bcast:15 row_mask:0xa bank_mask:0xf
    v_add_f32_dpp v182, v182, v182 row_bcast:15 row_mask:0xa bank_mask:0xf
    v_add_f32_dpp v176, v176, v176 row_bcast:31 row_mask:0xc bank_mask:0xf
    v_add_f32_dpp v178, v178, v178 row_bcast:31 row_mask:0xc bank_mask:0xf
    v_add_f32_dpp v180, v180, v180 row_bcast:31 row_mask:0xc bank_mask:0xf
    v_add_f32_dpp v182, v182, v182 row_bcast:31 row_mask:0xc bank_mask:0xf
    v_readlane_b32 s46, v176, 63
    buffer_load_dwordx4 a[168:171], v6, s[12:15], 0 offen offset:0 sc1
    v_readlane_b32 s47, v178, 63
    v_readlane_b32 s48, v180, 63
    v_readlane_b32 s49, v182, 63
    v_mov_b32 v144, 0x3acccccd
    v_pk_mul_f32 v[146:147], s[46:47], v[144:145] op_sel_hi:[1,0]
    v_pk_mul_f32 v[184:185], s[48:49], v[144:145] op_sel_hi:[1,0]
    v_pk_fma_f32 v[184:185], v[146:147], v[146:147], v[184:185] neg_lo:[1,0,0] neg_hi:[1,0,0]
    v_max_f32 v184, 0, v184
    v_max_f32 v185, 0, v185
    v_add_f32 v184, 0x3727c5ac, v184
    v_add_f32 v185, 0x3727c5ac, v185
    v_rsq_f32 v184, v184
    buffer_load_dwordx4 a[172:175], v6, s[12:15], 0 offen offset:1024 sc1
    v_rsq_f32 v185, v185
    s_nop 0
    v_pk_mul_f32 v[186:187], v[146:147], v[184:185] neg_lo:[1,0] neg_hi:[1,0]
    v_mov_b32 v188, v185
    v_mov_b32 v190, v187
    v_pk_fma_f32 v[152:153], v[108:109], v[184:185], v[186:187] op_sel_hi:[1,0,0]
    v_pk_fma_f32 v[154:155], v[110:111], v[184:185], v[186:187] op_sel_hi:[1,0,0]
    v_pk_fma_f32 v[156:157], v[112:113], v[188:189], v[190:191] op_sel_hi:[1,0,0]
    v_pk_fma_f32 v[158:159], v[114:115], v[188:189], v[190:191] op_sel_hi:[1,0,0]
    s_waitcnt lgkmcnt(2)
    v_pk_fma_f32 v[152:153], v[152:153], v[60:61], v[72:73]
    v_pk_fma_f32 v[154:155], v[154:155], v[62:63], v[74:75]
    v_pk_fma_f32 v[156:157], v[156:157], v[60:61], v[72:73]
    v_pk_fma_f32 v[158:159], v[158:159], v[62:63], v[74:75]
    buffer_load_dwordx4 a[176:179], v6, s[12:15], 0 offen offset:2048 sc1
    v_cvt_pk_bf16_f32 v96, v152, v153
    v_cvt_pk_bf16_f32 v97, v154, v155
    v_cvt_pk_bf16_f32 v98, v156, v157
    v_cvt_pk_bf16_f32 v99, v158, v159
    v_pk_fma_f32 v[160:161], v[116:117], v[184:185], v[186:187] op_sel_hi:[1,0,0]
    v_pk_fma_f32 v[162:163], v[118:119], v[184:185], v[186:187] op_sel_hi:[1,0,0]
    v_pk_fma_f32 v[164:165], v[120:121], v[188:189], v[190:191] op_sel_hi:[1,0,0]
    v_pk_fma_f32 v[166:167], v[122:123], v[188:189], v[190:191] op_sel_hi:[1,0,0]
    s_waitcnt lgkmcnt(1)
    v_pk_fma_f32 v[160:161], v[160:161], v[64:65], v[76:77]
    v_pk_fma_f32 v[162:163], v[162:163], v[66:67], v[78:79]
    v_pk_fma_f32 v[164:165], v[164:165], v[64:65], v[76:77]
    v_pk_fma_f32 v[166:167], v[166:167], v[66:67], v[78:79]
    buffer_load_dwordx4 a[180:183], v6, s[12:15], 0 offen offset:3072 sc1
    v_add_u32 v6, 0x1000, v6
    v_cvt_pk_bf16_f32 v100, v160, v161
    v_cvt_pk_bf16_f32 v101, v162, v163
    v_cvt_pk_bf16_f32 v102, v164, v165
    v_cvt_pk_bf16_f32 v103, v166, v167
    v_permlane16_swap_b32 v96, v98
    v_permlane16_swap_b32 v97, v99
    v_or_b32 v96, 1, v96
    ds_write_b128 v18, v[96:99] offset:0
    v_pk_fma_f32 v[168:169], v[124:125], v[184:185], v[186:187] op_sel_hi:[1,0,0]
    v_pk_fma_f32 v[170:171], v[126:127], v[184:185], v[186:187] op_sel_hi:[1,0,0]
    v_pk_fma_f32 v[172:173], v[128:129], v[188:189], v[190:191] op_sel_hi:[1,0,0]
    v_pk_fma_f32 v[174:175], v[130:131], v[188:189], v[190:191] op_sel_hi:[1,0,0]
    buffer_load_dwordx4 a[184:187], v6, s[12:15], 0 offen offset:0 sc1
    s_waitcnt lgkmcnt(1)
    v_pk_fma_f32 v[168:169], v[168:169], v[68:69], v[80:81]
    v_pk_fma_f32 v[170:171], v[170:171], v[70:71], v[82:83]
    v_pk_fma_f32 v[172:173], v[172:173], v[68:69], v[80:81]
    v_pk_fma_f32 v[174:175], v[174:175], v[70:71], v[82:83]
    v_cvt_pk_bf16_f32 v104, v168, v169
    v_cvt_pk_bf16_f32 v105, v170, v171
    v_cvt_pk_bf16_f32 v106, v172, v173
    v_cvt_pk_bf16_f32 v107, v174, v175
    v_permlane16_swap_b32 v100, v102
    v_permlane16_swap_b32 v101, v103
    v_or_b32 v100, 1, v100
    ds_write_b128 v19, v[100:103] offset:0
    buffer_load_dwordx4 a[188:191], v6, s[12:15], 0 offen offset:1024 sc1
    v_cvt_pk_bf16_f32 v84, v108, v109
    v_cvt_pk_bf16_f32 v85, v110, v111
    v_permlane16_swap_b32 v104, v106
    v_permlane16_swap_b32 v105, v107
    v_or_b32 v104, 1, v104
    s_mov_b32 exec_hi, 0
    ds_write_b128 v20, v[104:107] offset:0
    s_mov_b64 exec, -1
    s_lshr_b32 s42, s3, 1
    s_mul_i32 s42, s42, 20480
    s_and_b32 s24, s21, 1
    s_lshl_b32 s24, s24, 7
    s_add_u32 s42, s42, s24
    s_add_u32 s42, s42, 5505024
    s_add_u32 s44, s42, 8192
    s_add_u32 s45, s42, 16384
    buffer_load_dword v11, v2, s[12:15], s89 offen offset:1024 sc1
    s_waitcnt lgkmcnt(0)
    s_barrier
    ds_read_b128 v[48:51], v12 offset:0
    ds_read_b128 v[52:55], v12 offset:4096
    ds_read_b128 v[56:59], v12 offset:8192
    v_cvt_pk_bf16_f32 v86, v112, v113
    v_cvt_pk_bf16_f32 v87, v114, v115
    v_cvt_pk_bf16_f32 v88, v116, v117
    v_cvt_pk_bf16_f32 v89, v118, v119
    v_cvt_pk_bf16_f32 v90, v120, v121
    v_cvt_pk_bf16_f32 v91, v122, v123
    v_cvt_pk_bf16_f32 v92, v124, v125
    v_cvt_pk_bf16_f32 v93, v126, v127
    v_cvt_pk_bf16_f32 v94, v128, v129
    v_cvt_pk_bf16_f32 v95, v130, v131
    s_waitcnt lgkmcnt(2)
    buffer_store_dwordx4 v[48:51], v22, s[12:15], s42 offen sc1
    s_waitcnt lgkmcnt(1)
    buffer_store_dwordx4 v[52:55], v22, s[12:15], s44 offen sc1
    s_cmp_lt_u32 s22, 2
    s_cselect_b64 exec, -1, 0
    s_waitcnt lgkmcnt(0)
    buffer_store_dwordx4 v[56:59], v22, s[12:15], s45 offen sc1
    s_mov_b64 exec, -1
    v_permlane16_swap_b32 v84, v86
    v_permlane16_swap_b32 v85, v87
    v_permlane16_swap_b32 v88, v90
    v_permlane16_swap_b32 v89, v91
    v_permlane16_swap_b32 v92, v94
    v_permlane16_swap_b32 v93, v95
    ds_write_b128 v21, v[84:87] offset:10240
    ds_write_b128 v21, v[88:91] offset:10272
    s_mov_b32 exec_hi, 0
    ds_write_b128 v21, v[92:95] offset:10304
    s_mov_b64 exec, -1
    s_add_u32 s24, s30, 100352
    v_add_u32 v23, s24, v5
    s_mul_i32 s43, s3, 10240
    s_add_u32 s43, s43, s30
    s_add_u32 s29, s43, 8093696
    s_waitcnt lgkmcnt(0)
    ds_read_b128 v[244:247], v23 offset:0
    ds_read_b128 v[248:251], v23 offset:1024
    ds_read_b128 v[252:255], v23 offset:2048
    s_mul_i32 s24, s20, 163840
    s_add_u32 s24, s24, 5505024
    s_add_u32 s16, s4, s24
    s_addc_u32 s17, s5, 0
    s_mov_b32 s18, 163840
    s_mov_b32 s19, 0x00020000
    s_and_b32 s52, s22, 2
    s_add_u32 s52, s52, s22
    s_mul_i32 s52, s52, 20480
    s_add_u32 s53, s52, 40960
    s_lshl_b32 s54, s20, 8
    s_add_u32 s54, s54, 36864
    s_add_u32 s55, s54, 4096
    s_add_u32 s51, s54, 128
    s_mov_b32 s36, s40
    s_mov_b32 s37, s41
    s_mov_b32 s38, 2621440
    s_mov_b32 s39, 0x00020000
    s_waitcnt vmcnt(0)
    s_add_u32 m0, s52, 0
    s_nop 0
    buffer_load_dwordx4 v5, s[16:19], m0 offen offset:0 sc1 lds
    buffer_load_dwordx4 v5, s[16:19], m0 offen offset:1024 sc1 lds
    buffer_load_dwordx4 v5, s[16:19], m0 offen offset:2048 sc1 lds
    buffer_load_dwordx4 v5, s[16:19], m0 offen offset:3072 sc1 lds
    s_add_u32 m0, s52, 4096
    s_nop 0
    buffer_load_dwordx4 v5, s[16:19], m0 offen offset:0 sc1 lds
    buffer_load_dwordx4 v5, s[16:19], m0 offen offset:1024 sc1 lds
    buffer_load_dwordx4 v5, s[16:19], m0 offen offset:2048 sc1 lds
    buffer_load_dwordx4 v5, s[16:19], m0 offen offset:3072 sc1 lds
    v_readfirstlane_b32 s24, v11
    s_nop 0
    s_cmp_lg_u32 s24, 1
    s_nop 1
    s_cbranch_scc1 LF0_slow
LF0_ok:
    buffer_load_dwordx4 a[192:195], v6, s[12:15], 0 offen offset:2048 sc1
    buffer_load_dwordx4 a[196:199], v6, s[12:15], 0 offen offset:3072 sc1
    v_add_u32 v6, 0x1000, v6
    buffer_load_dwordx4 a[200:203], v6, s[12:15], 0 offen offset:0 sc1
    buffer_load_dwordx4 a[204:207], v6, s[12:15], 0 offen offset:1024 sc1
    v_mov_b32 v12, v5
    v_add_u32 v13, 81920, v5
    s_lshl_b32 s24, s56, 2
    s_add_u32 s24, s24, s22
    s_mul_i32 s24, s24, 61440
    s_add_u32 s24, s24, 17039360
    v_add_u32 v14, s24, v5
    s_lshl_b32 s24, s20, 1
    s_add_u32 s24, s24, s57
    s_lshl_b32 s24, s24, 2
    s_mul_i32 s33, s22, 12288
    s_add_u32 s33, s33, 10747904
    s_mul_i32 s42, s24, 49152
    s_add_u32 s42, s42, s33
    s_add_u32 s43, s42, 49152
    s_add_u32 s44, s42, 98304
    s_add_u32 s45, s42, 147456
    v_mul_u32_u24 v19, 26, v4
    v_lshrrev_b32 v19, 8, v19
    v_mul_u32_u24 v20, 10, v19
    v_sub_u32 v20, v4, v20
    v_mul_u32_u24 v18, 336, v19
    v_lshl_add_u32 v18, v20, 4, v18
    s_mul_i32 s25, s22, 1344
    v_add_u32 v18, s25, v18
    v_mul_u32_u24 v16, 1280, v19
    v_lshl_add_u32 v16, v20, 4, v16
    v_mul_u32_u24 v15, 40960, v19
    v_lshl_add_u32 v15, v20, 4, v15
    v_lshlrev_b32 v20, 5, v20
    v_mul_u32_u24 v17, 336, v7
    s_mul_i32 s25, s22, 5376
    v_add_u32 v17, s25, v17
    v_mul_u32_u24 v11, 5, v8
    v_add_u32 v19, 1, v11
    v_lshrrev_b32 v19, 1, v19
    v_lshl_add_u32 v19, v19, 4, v17
    v_lshrrev_b32 v11, 1, v11
    v_lshl_add_u32 v17, v11, 4, v17
    v_and_b32 v11, 1, v8
    v_mul_u32_u24 v11, 160, v11
    v_add_u32 v17, v17, v11
    v_sub_u32 v19, v19, v11
    v_add_u32 v19, 160, v19
    s_mul_i32 s30, s56, 160
    s_lshl_b32 s25, s24, 2
    s_add_u32 s25, s25, s22
    s_mul_i32 s46, s25, 5120
    s_add_u32 s46, s46, s30
    s_add_u32 s46, s46, 8126464
    s_add_u32 s47, s46, 20480
    s_add_u32 s48, s46, 40960
    s_add_u32 s49, s46, 61440
    s_lshl_b32 s25, s20, 7
    s_lshl_b32 s26, s57, 4
    s_add_u32 s25, s25, s26
    s_add_u32 s25, s25, s22
    s_mul_i32 s25, s25, 1280
    s_add_u32 s25, s25, s30
    s_add_u32 s26, s25, 5120
    s_add_u32 s27, s25, 10240
    s_add_u32 s28, s25, 15360
    s_lshl_b32 s30, s30, 1
    s_add_u32 s30, s30, 12800
    v_cmp_gt_u32 vcc, 32, v4
    v_mov_b32 v186, 0x7ff00000
    s_nop 0
    v_cndmask_b32 v186, v186, v5, vcc
    s_mov_b32 s34, -1
    s_mov_b32 s35, 0xff
    v_add_u32 v187, s52, v5
    s_waitcnt vmcnt(8)
    ds_read2st64_b32 v[172:173], v187 offset0:0 offset1:4
    ds_read2st64_b32 v[174:175], v187 offset0:8 offset1:12
    s_waitcnt lgkmcnt(0)
    v_bitop3_b32 v172, v172, v173, v174 bitop3:0x80
    v_bitop3_b32 v172, v172, v175, 1 bitop3:0x80
    v_cmp_eq_u32 s[62:63], 0, v172
    s_nop 0
    s_cmp_lg_u64 s[62:63], 0
    s_cbranch_scc1 LV0_slow
LV0_ok:
    s_barrier
    s_cmp_lg_u32 s22, 0
    s_cbranch_scc1 LH1_sig
    s_mov_b64 exec, 1
    buffer_atomic_add v3, v2, s[12:15], s54 offen sc1
    s_mov_b64 exec, -1
LH1_sig:
    ds_read_b128 v[24:27], v12 offset:0
    ds_read_b128 v[28:31], v12 offset:20480
    ds_read_b128 v[32:35], v13 offset:0
    ds_read_b128 v[36:39], v13 offset:20480
    ds_read_b128 v[40:43], v12 offset:1024
    ds_read_b128 v[44:47], v12 offset:21504
    ds_read_b128 v[48:51], v13 offset:1024
    ds_read_b128 v[52:55], v13 offset:21504
    s_waitcnt lgkmcnt(7)
    v_mfma_f32_16x16x32_bf16 v[56:59], a[0:3], v[24:27], 0
    s_add_u32 m0, s52, 8192
    v_mfma_f32_16x16x32_bf16 v[72:75], a[4:7], v[24:27], 0
    buffer_load_dwordx4 v5, s[16:19], m0 offen offset:0 sc1 lds
    v_mfma_f32_16x16x32_bf16 v[88:91], a[8:11], v[24:27], 0
    ds_read_b128 v[24:27], v12 offset:2048
    s_waitcnt lgkmcnt(7)
    v_mfma_f32_16x16x32_bf16 v[60:63], a[0:3], v[28:31], 0
    v_mfma_f32_16x16x32_bf16 v[76:79], a[4:7], v[28:31], 0
    buffer_load_dwordx4 v5, s[16:19], m0 offen offset:1024 sc1 lds
    v_mfma_f32_16x16x32_bf16 v[92:95], a[8:11], v[28:31], 0
    ds_read_b128 v[28:31], v12 offset:22528
    s_waitcnt lgkmcnt(7)
    v_mfma_f32_16x16x32_bf16 v[64:67], a[0:3], v[32:35], 0
    v_mfma_f32_16x16x32_bf16 v[80:83], a[4:7], v[32:35], 0
    v_mfma_f32_16x16x32_bf16 v[96:99], a[8:11], v[32:35], 0
    ds_read_b128 v[32:35], v13 offset:2048
    s_waitcnt lgkmcnt(7)
    v_mfma_f32_16x16x32_bf16 v[68:71], a[0:3], v[36:39], 0
    buffer_load_dwordx4 v5, s[16:19], m0 offen offset:2048 sc1 lds
    v_mfma_f32_16x16x32_bf16 v[84:87], a[4:7], v[36:39], 0
    s_waitcnt lgkmcnt(3)
    v_mfma_f32_16x16x32_bf16 v[100:103], a[8:11], v[36:39], 0
    ds_read_b128 v[36:39], v13 offset:22528
    s_waitcnt vmcnt(7)
    v_mfma_f32_16x16x32_bf16 v[56:59], a[12:15], v[40:43], v[56:59]
    ds_read2st64_b32 v[172:173], v187 offset0:16 offset1:20
    v_mfma_f32_16x16x32_bf16 v[72:75], a[16:19], v[40:43], v[72:75]
    ds_read2st64_b32 v[174:175], v187 offset0:24 offset1:28
    v_mfma_f32_16x16x32_bf16 v[88:91], a[20:23], v[40:43], v[88:91]
    ds_read_b128 v[40:43], v12 offset:3072
    v_mfma_f32_16x16x32_bf16 v[60:63], a[12:15], v[44:47], v[60:63]
    buffer_load_dwordx4 v5, s[16:19], m0 offen offset:3072 sc1 lds
    v_mfma_f32_16x16x32_bf16 v[76:79], a[16:19], v[44:47], v[76:79]
    s_add_u32 m0, s52, 12288
    v_mfma_f32_16x16x32_bf16 v[92:95], a[20:23], v[44:47], v[92:95]
    ds_read_b128 v[44:47], v12 offset:23552
    v_mfma_f32_16x16x32_bf16 v[64:67], a[12:15], v[48:51], v[64:67]
    s_waitcnt lgkmcnt(2)
    v_bitop3_b32 v172, v172, v173, v174 bitop3:0x80
    v_mfma_f32_16x16x32_bf16 v[80:83], a[16:19], v[48:51], v[80:83]
    buffer_load_dwordx4 v5, s[16:19], m0 offen offset:0 sc1 lds
    v_mfma_f32_16x16x32_bf16 v[96:99], a[20:23], v[48:51], v[96:99]
    ds_read_b128 v[48:51], v13 offset:3072
    v_mfma_f32_16x16x32_bf16 v[68:71], a[12:15], v[52:55], v[68:71]
    v_bitop3_b32 v172, v172, v175, 1 bitop3:0x80
    v_mfma_f32_16x16x32_bf16 v[84:87], a[16:19], v[52:55], v[84:87]
    v_cmp_eq_u32 s[62:63], 0, v172
    v_mfma_f32_16x16x32_bf16 v[100:103], a[20:23], v[52:55], v[100:103]
    ds_read_b128 v[52:55], v13 offset:23552
    s_nop 0
    s_cmp_lg_u64 s[62:63], 0
    s_cbranch_scc1 LV1_slow
LV1_ok:
    s_barrier
    v_mfma_f32_16x16x32_bf16 v[56:59], a[24:27], v[24:27], v[56:59]
    buffer_load_dwordx4 v5, s[16:19], m0 offen offset:1024 sc1 lds
    v_mfma_f32_16x16x32_bf16 v[72:75], a[28:31], v[24:27], v[72:75]
    v_mfma_f32_16x16x32_bf16 v[88:91], a[32:35], v[24:27], v[88:91]
    ds_read_b128 v[24:27], v12 offset:4096
    v_mfma_f32_16x16x32_bf16 v[60:63], a[24:27], v[28:31], v[60:63]
    v_mfma_f32_16x16x32_bf16 v[76:79], a[28:31], v[28:31], v[76:79]
    buffer_load_dwordx4 v5, s[16:19], m0 offen offset:2048 sc1 lds
    v_mfma_f32_16x16x32_bf16 v[92:95], a[32:35], v[28:31], v[92:95]
    ds_read_b128 v[28:31], v12 offset:24576
    v_mfma_f32_16x16x32_bf16 v[64:67], a[24:27], v[32:35], v[64:67]
    v_mfma_f32_16x16x32_bf16 v[80:83], a[28:31], v[32:35], v[80:83]
    v_mfma_f32_16x16x32_bf16 v[96:99], a[32:35], v[32:35], v[96:99]
    ds_read_b128 v[32:35], v13 offset:4096
    v_mfma_f32_16x16x32_bf16 v[68:71], a[24:27], v[36:39], v[68:71]
    buffer_load_dwordx4 v5, s[16:19], m0 offen offset:3072 sc1 lds
    v_mfma_f32_16x16x32_bf16 v[84:87], a[28:31], v[36:39], v[84:87]
    s_waitcnt lgkmcnt(3)
    v_mfma_f32_16x16x32_bf16 v[100:103], a[32:35], v[36:39], v[100:103]
    ds_read_b128 v[36:39], v13 offset:24576
    v_mfma_f32_16x16x32_bf16 v[56:59], a[36:39], v[40:43], v[56:59]
    s_add_u32 m0, s52, 16384
    v_mfma_f32_16x16x32_bf16 v[72:75], a[40:43], v[40:43], v[72:75]
    v_mfma_f32_16x16x32_bf16 v[88:91], a[44:47], v[40:43], v[88:91]
    ds_read_b128 v[40:43], v12 offset:5120
    v_mfma_f32_16x16x32_bf16 v[60:63], a[36:39], v[44:47], v[60:63]
    buffer_load_dwordx4 v5, s[16:19], m0 offen offset:0 sc1 lds
    v_mfma_f32_16x16x32_bf16 v[76:79], a[40:43], v[44:47], v[76:79]
    v_mfma_f32_16x16x32_bf16 v[92:95], a[44:47], v[44:47], v[92:95]
    ds_read_b128 v[44:47], v12 offset:25600
    v_mfma_f32_16x16x32_bf16 v[64:67], a[36:39], v[48:51], v[64:67]
    v_mfma_f32_16x16x32_bf16 v[80:83], a[40:43], v[48:51], v[80:83]
    buffer_load_dwordx4 v5, s[16:19], m0 offen offset:1024 sc1 lds
    v_mfma_f32_16x16x32_bf16 v[96:99], a[44:47], v[48:51], v[96:99]
    ds_read_b128 v[48:51], v13 offset:5120
    v_mfma_f32_16x16x32_bf16 v[68:71], a[36:39], v[52:55], v[68:71]
    v_mfma_f32_16x16x32_bf16 v[84:87], a[40:43], v[52:55], v[84:87]
    s_waitcnt lgkmcnt(3)
    v_mfma_f32_16x16x32_bf16 v[100:103], a[44:47], v[52:55], v[100:103]
    ds_read_b128 v[52:55], v13 offset:25600
    s_waitcnt vmcnt(6)
    v_mfma_f32_16x16x32_bf16 v[56:59], a[48:51], v[24:27], v[56:59]
    buffer_load_dwordx4 v5, s[16:19], m0 offen offset:2048 sc1 lds
    v_mfma_f32_16x16x32_bf16 v[72:75], a[52:55], v[24:27], v[72:75]
    ds_read2st64_b32 v[172:173], v187 offset0:32 offset1:36
    v_mfma_f32_16x16x32_bf16 v[88:91], a[56:59], v[24:27], v[88:91]
    ds_read_b128 v[24:27], v12 offset:6144
    v_mfma_f32_16x16x32_bf16 v[60:63], a[48:51], v[28:31], v[60:63]
    ds_read2st64_b32 v[174:175], v187 offset0:40 offset1:44
    v_mfma_f32_16x16x32_bf16 v[76:79], a[52:55], v[28:31], v[76:79]
    buffer_load_dwordx4 v5, s[16:19], m0 offen offset:3072 sc1 lds
    v_mfma_f32_16x16x32_bf16 v[92:95], a[56:59], v[28:31], v[92:95]
    ds_read_b128 v[28:31], v12 offset:26624
    v_mfma_f32_16x16x32_bf16 v[64:67], a[48:51], v[32:35], v[64:67]
    s_waitcnt lgkmcnt(1)
    v_bitop3_b32 v172, v172, v173, v174 bitop3:0x80
    v_mfma_f32_16x16x32_bf16 v[80:83], a[52:55], v[32:35], v[80:83]
    v_bitop3_b32 v172, v172, v175, 1 bitop3:0x80
    v_mfma_f32_16x16x32_bf16 v[96:99], a[56:59], v[32:35], v[96:99]
    ds_read_b128 v[32:35], v13 offset:6144
    v_mfma_f32_16x16x32_bf16 v[68:71], a[48:51], v[36:39], v[68:71]
    buffer_load_dwordx4 a[208:211], v6, s[12:15], 0 offen offset:2048 sc1
    v_mfma_f32_16x16x32_bf16 v[84:87], a[52:55], v[36:39], v[84:87]
    v_cmp_eq_u32 s[62:63], 0, v172
    v_mfma_f32_16x16x32_bf16 v[100:103], a[56:59], v[36:39], v[100:103]
    ds_read_b128 v[36:39], v13 offset:26624
    v_mfma_f32_16x16x32_bf16 v[56:59], a[60:63], v[40:43], v[56:59]
    s_nop 0
    v_mfma_f32_16x16x32_bf16 v[72:75], a[64:67], v[40:43], v[72:75]
    s_cmp_lg_u64 s[62:63], 0
    s_cbranch_scc1 LV2_slow
LV2_ok:
    v_mfma_f32_16x16x32_bf16 v[88:91], a[68:71], v[40:43], v[88:91]
    ds_read_b128 v[40:43], v12 offset:7168
    v_mfma_f32_16x16x32_bf16 v[60:63], a[60:63], v[44:47], v[60:63]
    buffer_load_dwordx4 a[212:215], v6, s[12:15], 0 offen offset:3072 sc1
    v_mfma_f32_16x16x32_bf16 v[76:79], a[64:67], v[44:47], v[76:79]
    v_add_u32 v6, 0x1000, v6
    v_mfma_f32_16x16x32_bf16 v[92:95], a[68:71], v[44:47], v[92:95]
    ds_read_b128 v[44:47], v12 offset:27648
    v_mfma_f32_16x16x32_bf16 v[64:67], a[60:63], v[48:51], v[64:67]
    v_mfma_f32_16x16x32_bf16 v[80:83], a[64:67], v[48:51], v[80:83]
    buffer_load_dword v11, v2, s[12:15], s54 offen sc1
    v_mfma_f32_16x16x32_bf16 v[96:99], a[68:71], v[48:51], v[96:99]
    ds_read_b128 v[48:51], v13 offset:7168
    v_mfma_f32_16x16x32_bf16 v[68:71], a[60:63], v[52:55], v[68:71]
    v_mfma_f32_16x16x32_bf16 v[84:87], a[64:67], v[52:55], v[84:87]
    s_waitcnt lgkmcnt(3)
    v_mfma_f32_16x16x32_bf16 v[100:103], a[68:71], v[52:55], v[100:103]
    ds_read_b128 v[52:55], v13 offset:27648
    s_barrier
    v_mfma_f32_16x16x32_bf16 v[56:59], a[72:75], v[24:27], v[56:59]
    buffer_load_dwordx4 a[216:219], v6, s[12:15], 0 offen offset:0 sc1
    v_mfma_f32_16x16x32_bf16 v[72:75], a[76:79], v[24:27], v[72:75]
    v_mfma_f32_16x16x32_bf16 v[88:91], a[80:83], v[24:27], v[88:91]
    ds_read_b128 v[24:27], v12 offset:8192
    v_mfma_f32_16x16x32_bf16 v[60:63], a[72:75], v[28:31], v[60:63]
    v_mfma_f32_16x16x32_bf16 v[76:79], a[76:79], v[28:31], v[76:79]
    buffer_load_dwordx4 a[220:223], v6, s[12:15], 0 offen offset:1024 sc1
    v_mfma_f32_16x16x32_bf16 v[92:95], a[80:83], v[28:31], v[92:95]
    ds_read_b128 v[28:31], v12 offset:28672
    v_mfma_f32_16x16x32_bf16 v[64:67], a[72:75], v[32:35], v[64:67]
    v_mfma_f32_16x16x32_bf16 v[80:83], a[76:79], v[32:35], v[80:83]
    v_mfma_f32_16x16x32_bf16 v[96:99], a[80:83], v[32:35], v[96:99]
    ds_read_b128 v[32:35], v13 offset:8192
    v_mfma_f32_16x16x32_bf16 v[68:71], a[72:75], v[36:39], v[68:71]
    buffer_load_dwordx4 a[224:227], v6, s[12:15], 0 offen offset:2048 sc1
    v_mfma_f32_16x16x32_bf16 v[84:87], a[76:79], v[36:39], v[84:87]
    s_waitcnt lgkmcnt(3)
    v_mfma_f32_16x16x32_bf16 v[100:103], a[80:83], v[36:39], v[100:103]
    ds_read_b128 v[36:39], v13 offset:28672
    s_waitcnt vmcnt(6)
    v_mfma_f32_16x16x32_bf16 v[56:59], a[84:87], v[40:43], v[56:59]
    ds_read2st64_b32 v[172:173], v187 offset0:48 offset1:52
    v_mfma_f32_16x16x32_bf16 v[72:75], a[88:91], v[40:43], v[72:75]
    ds_read2st64_b32 v[174:175], v187 offset0:56 offset1:60
    v_mfma_f32_16x16x32_bf16 v[88:91], a[92:95], v[40:43], v[88:91]
    ds_read_b128 v[40:43], v12 offset:9216
    v_mfma_f32_16x16x32_bf16 v[60:63], a[84:87], v[44:47], v[60:63]
    buffer_load_dwordx4 a[228:231], v6, s[12:15], 0 offen offset:3072 sc1
    v_mfma_f32_16x16x32_bf16 v[76:79], a[88:91], v[44:47], v[76:79]
    v_add_u32 v6, 0x1000, v6
    v_mfma_f32_16x16x32_bf16 v[92:95], a[92:95], v[44:47], v[92:95]
    ds_read_b128 v[44:47], v12 offset:29696
    v_mfma_f32_16x16x32_bf16 v[64:67], a[84:87], v[48:51], v[64:67]
    ds_read2st64_b32 v[176:177], v187 offset0:64 offset1:68
    v_mfma_f32_16x16x32_bf16 v[80:83], a[88:91], v[48:51], v[80:83]
    buffer_load_dwordx4 a[232:235], v6, s[12:15], 0 offen offset:0 sc1
    v_mfma_f32_16x16x32_bf16 v[96:99], a[92:95], v[48:51], v[96:99]
    ds_read_b128 v[48:51], v13 offset:9216
    v_mfma_f32_16x16x32_bf16 v[68:71], a[84:87], v[52:55], v[68:71]
    ds_read2st64_b32 v[178:179], v187 offset0:72 offset1:76
    v_mfma_f32_16x16x32_bf16 v[84:87], a[88:91], v[52:55], v[84:87]
    s_waitcnt lgkmcnt(3)
    v_mfma_f32_16x16x32_bf16 v[100:103], a[92:95], v[52:55], v[100:103]
    ds_read_b128 v[52:55], v13 offset:29696
    v_mfma_f32_16x16x32_bf16 v[56:59], a[96:99], v[24:27], v[56:59]
    buffer_load_dwordx4 a[236:239], v6, s[12:15], 0 offen offset:1024 sc1
    v_mfma_f32_16x16x32_bf16 v[72:75], a[100:103], v[24:27], v[72:75]
    v_bitop3_b32 v172, v172, v173, v174 bitop3:0x80
    v_mfma_f32_16x16x32_bf16 v[88:91], a[104:107], v[24:27], v[88:91]
    ds_read_b128 v[24:27], v12 offset:10240
    v_mfma_f32_16x16x32_bf16 v[60:63], a[96:99], v[28:31], v[60:63]
    s_waitcnt lgkmcnt(4)
    v_bitop3_b32 v172, v172, v175, v176 bitop3:0x80
    v_mfma_f32_16x16x32_bf16 v[76:79], a[100:103], v[28:31], v[76:79]
    buffer_store_dwordx4 v[244:247], v5, s[12:15], s29 offen offset:0 sc1
    v_mfma_f32_16x16x32_bf16 v[92:95], a[104:107], v[28:31], v[92:95]
    ds_read_b128 v[28:31], v12 offset:30720
    v_mfma_f32_16x16x32_bf16 v[64:67], a[96:99], v[32:35], v[64:67]
    s_waitcnt lgkmcnt(3)
    v_bitop3_b32 v172, v172, v177, v178 bitop3:0x80
    v_mfma_f32_16x16x32_bf16 v[80:83], a[100:103], v[32:35], v[80:83]
    v_bitop3_b32 v172, v172, v179, 1 bitop3:0x80
    v_mfma_f32_16x16x32_bf16 v[96:99], a[104:107], v[32:35], v[96:99]
    ds_read_b128 v[32:35], v13 offset:10240
    v_mfma_f32_16x16x32_bf16 v[68:71], a[96:99], v[36:39], v[68:71]
    buffer_store_dwordx4 v[248:251], v5, s[12:15], s29 offen offset:1024 sc1
    v_mfma_f32_16x16x32_bf16 v[84:87], a[100:103], v[36:39], v[84:87]
    s_waitcnt lgkmcnt(3)
    v_mfma_f32_16x16x32_bf16 v[100:103], a[104:107], v[36:39], v[100:103]
    ds_read_b128 v[36:39], v13 offset:30720
    v_mfma_f32_16x16x32_bf16 v[56:59], a[108:111], v[40:43], v[56:59]
    v_cmp_eq_u32 s[62:63], 0, v172
    v_mfma_f32_16x16x32_bf16 v[72:75], a[112:115], v[40:43], v[72:75]
    s_nop 0
    v_mfma_f32_16x16x32_bf16 v[88:91], a[116:119], v[40:43], v[88:91]
    ds_read_b128 v[40:43], v12 offset:11264
    v_mfma_f32_16x16x32_bf16 v[60:63], a[108:111], v[44:47], v[60:63]
    buffer_store_dwordx4 v[252:255], v186, s[12:15], s29 offen offset:2048 sc1
    v_mfma_f32_16x16x32_bf16 v[76:79], a[112:115], v[44:47], v[76:79]
    s_waitcnt vmcnt(9)
    v_readfirstlane_b32 s33, v11
    s_nop 0
    s_cmp_ge_u32 s33, 16
    s_cbranch_scc0 LH1_spin
LH1_ok:
    v_mfma_f32_16x16x32_bf16 v[92:95], a[116:119], v[44:47], v[92:95]
    ds_read_b128 v[44:47], v12 offset:31744
    v_mfma_f32_16x16x32_bf16 v[64:67], a[108:111], v[48:51], v[64:67]
    s_add_u32 m0, s53, 0
    v_mfma_f32_16x16x32_bf16 v[80:83], a[112:115], v[48:51], v[80:83]
    buffer_load_dwordx4 v5, s[16:19], m0 offen offset:0 sc1 lds
    v_mfma_f32_16x16x32_bf16 v[96:99], a[116:119], v[48:51], v[96:99]
    ds_read_b128 v[48:51], v13 offset:11264
    v_mfma_f32_16x16x32_bf16 v[68:71], a[108:111], v[52:55], v[68:71]
    s_cmp_lg_u64 s[62:63], 0
    s_cbranch_scc1 LV3_slow
LV3_ok:
    v_mfma_f32_16x16x32_bf16 v[84:87], a[112:115], v[52:55], v[84:87]
    s_waitcnt lgkmcnt(3)
    v_mfma_f32_16x16x32_bf16 v[100:103], a[116:119], v[52:55], v[100:103]
    ds_read_b128 v[52:55], v13 offset:31744
    s_barrier
    v_mfma_f32_16x16x32_bf16 v[56:59], a[120:123], v[24:27], v[56:59]
    buffer_load_dwordx4 v5, s[16:19], m0 offen offset:1024 sc1 lds
    v_mfma_f32_16x16x32_bf16 v[72:75], a[124:127], v[24:27], v[72:75]
    v_mfma_f32_16x16x32_bf16 v[88:91], a[128:131], v[24:27], v[88:91]
    ds_read_b128 v[24:27], v12 offset:12288
    v_mfma_f32_16x16x32_bf16 v[60:63], a[120:123], v[28:31], v[60:63]
    v_mfma_f32_16x16x32_bf16 v[76:79], a[124:127], v[28:31], v[76:79]
    buffer_load_dwordx4 v5, s[16:19], m0 offen offset:2048 sc1 lds
    v_mfma_f32_16x16x32_bf16 v[92:95], a[128:131], v[28:31], v[92:95]
    ds_read_b128 v[28:31], v12 offset:32768
    v_mfma_f32_16x16x32_bf16 v[64:67], a[120:123], v[32:35], v[64:67]
    v_mfma_f32_16x16x32_bf16 v[80:83], a[124:127], v[32:35], v[80:83]
    v_mfma_f32_16x16x32_bf16 v[96:99], a[128:131], v[32:35], v[96:99]
    ds_read_b128 v[32:35], v13 offset:12288
    v_mfma_f32_16x16x32_bf16 v[68:71], a[120:123], v[36:39], v[68:71]
    buffer_load_dwordx4 v5, s[16:19], m0 offen offset:3072 sc1 lds
    v_mfma_f32_16x16x32_bf16 v[84:87], a[124:127], v[36:39], v[84:87]
    s_waitcnt lgkmcnt(3)
    v_mfma_f32_16x16x32_bf16 v[100:103], a[128:131], v[36:39], v[100:103]
    ds_read_b128 v[36:39], v13 offset:32768
    v_mfma_f32_16x16x32_bf16 v[56:59], a[132:135], v[40:43], v[56:59]
    s_add_u32 m0, s53, 4096
    v_mfma_f32_16x16x32_bf16 v[72:75], a[136:139], v[40:43], v[72:75]
    v_mfma_f32_16x16x32_bf16 v[88:91], a[140:143], v[40:43], v[88:91]
    ds_read_b128 v[40:43], v12 offset:13312
    v_mfma_f32_16x16x32_bf16 v[60:63], a[132:135], v[44:47], v[60:63]
    buffer_load_dwordx4 v5, s[16:19], m0 offen offset:0 sc1 lds
    v_mfma_f32_16x16x32_bf16 v[76:79], a[136:139], v[44:47], v[76:79]
    v_mfma_f32_16x16x32_bf16 v[92:95], a[140:143], v[44:47], v[92:95]
    ds_read_b128 v[44:47], v12 offset:33792
    v_mfma_f32_16x16x32_bf16 v[64:67], a[132:135], v[48:51], v[64:67]
    v_mfma_f32_16x16x32_bf16 v[80:83], a[136:139], v[48:51], v[80:83]
    buffer_load_dwordx4 v5, s[16:19], m0 offen offset:1024 sc1 lds
    v_mfma_f32_16x16x32_bf16 v[96:99], a[140:143], v[48:51], v[96:99]
    ds_read_b128 v[48:51], v13 offset:13312
    v_mfma_f32_16x16x32_bf16 v[68:71], a[132:135], v[52:55], v[68:71]
    v_mfma_f32_16x16x32_bf16 v[84:87], a[136:139], v[52:55], v[84:87]
    s_waitcnt lgkmcnt(3)
    v_mfma_f32_16x16x32_bf16 v[100:103], a[140:143], v[52:55], v[100:103]
    ds_read_b128 v[52:55], v13 offset:33792
    v_mfma_f32_16x16x32_bf16 v[56:59], a[144:147], v[24:27], v[56:59]
    buffer_load_dwordx4 v5, s[16:19], m0 offen offset:2048 sc1 lds
    v_mfma_f32_16x16x32_bf16 v[72:75], a[148:151], v[24:27], v[72:75]
    v_mfma_f32_16x16x32_bf16 v[88:91], a[152:155], v[24:27], v[88:91]
    ds_read_b128 v[24:27], v12 offset:14336
    v_mfma_f32_16x16x32_bf16 v[60:63], a[144:147], v[28:31], v[60:63]
    v_mfma_f32_16x16x32_bf16 v[76:79], a[148:151], v[28:31], v[76:79]
    buffer_load_dwordx4 v5, s[16:19], m0 offen offset:3072 sc1 lds
    v_mfma_f32_16x16x32_bf16 v[92:95], a[152:155], v[28:31], v[92:95]
    ds_read_b128 v[28:31], v12 offset:34816
    v_mfma_f32_16x16x32_bf16 v[64:67], a[144:147], v[32:35], v[64:67]
    s_add_u32 m0, s53, 8192
    v_mfma_f32_16x16x32_bf16 v[80:83], a[148:151], v[32:35], v[80:83]
    v_mfma_f32_16x16x32_bf16 v[96:99], a[152:155], v[32:35], v[96:99]
    ds_read_b128 v[32:35], v13 offset:14336
    v_mfma_f32_16x16x32_bf16 v[68:71], a[144:147], v[36:39], v[68:71]
    buffer_load_dwordx4 v5, s[16:19], m0 offen offset:0 sc1 lds
    v_mfma_f32_16x16x32_bf16 v[84:87], a[148:151], v[36:39], v[84:87]
    s_waitcnt lgkmcnt(3)
    v_mfma_f32_16x16x32_bf16 v[100:103], a[152:155], v[36:39], v[100:103]
    ds_read_b128 v[36:39], v13 offset:34816
    v_mfma_f32_16x16x32_bf16 v[56:59], a[156:159], v[40:43], v[56:59]
    v_mfma_f32_16x16x32_bf16 v[72:75], a[160:163], v[40:43], v[72:75]
    v_mfma_f32_16x16x32_bf16 v[88:91], a[164:167], v[40:43], v[88:91]
    ds_read_b128 v[40:43], v12 offset:15360
    v_mfma_f32_16x16x32_bf16 v[60:63], a[156:159], v[44:47], v[60:63]
    buffer_load_dwordx4 v5, s[16:19], m0 offen offset:1024 sc1 lds
    v_mfma_f32_16x16x32_bf16 v[76:79], a[160:163], v[44:47], v[76:79]
    v_mfma_f32_16x16x32_bf16 v[92:95], a[164:167], v[44:47], v[92:95]
    ds_read_b128 v[44:47], v12 offset:35840
    v_mfma_f32_16x16x32_bf16 v[64:67], a[156:159], v[48:51], v[64:67]
    v_mfma_f32_16x16x32_bf16 v[80:83], a[160:163], v[48:51], v[80:83]
    buffer_load_dwordx4 v5, s[16:19], m0 offen offset:2048 sc1 lds
    v_mfma_f32_16x16x32_bf16 v[96:99], a[164:167], v[48:51], v[96:99]
    ds_read_b128 v[48:51], v13 offset:15360
    v_mfma_f32_16x16x32_bf16 v[68:71], a[156:159], v[52:55], v[68:71]
    v_mfma_f32_16x16x32_bf16 v[84:87], a[160:163], v[52:55], v[84:87]
    s_waitcnt lgkmcnt(3)
    v_mfma_f32_16x16x32_bf16 v[100:103], a[164:167], v[52:55], v[100:103]
    ds_read_b128 v[52:55], v13 offset:35840
    v_mfma_f32_16x16x32_bf16 v[56:59], a[168:171], v[24:27], v[56:59]
    buffer_load_dwordx4 v5, s[16:19], m0 offen offset:3072 sc1 lds
    v_mfma_f32_16x16x32_bf16 v[72:75], a[172:175], v[24:27], v[72:75]
    s_add_u32 m0, s53, 12288
    v_mfma_f32_16x16x32_bf16 v[88:91], a[176:179], v[24:27], v[88:91]
    ds_read_b128 v[24:27], v12 offset:16384
    v_mfma_f32_16x16x32_bf16 v[60:63], a[168:171], v[28:31], v[60:63]
    v_mfma_f32_16x16x32_bf16 v[76:79], a[172:175], v[28:31], v[76:79]
    buffer_load_dwordx4 v5, s[16:19], m0 offen offset:0 sc1 lds
    v_mfma_f32_16x16x32_bf16 v[92:95], a[176:179], v[28:31], v[92:95]
    ds_read_b128 v[28:31], v12 offset:36864
    v_mfma_f32_16x16x32_bf16 v[64:67], a[168:171], v[32:35], v[64:67]
    v_mfma_f32_16x16x32_bf16 v[80:83], a[172:175], v[32:35], v[80:83]
    v_mfma_f32_16x16x32_bf16 v[96:99], a[176:179], v[32:35], v[96:99]
    ds_read_b128 v[32:35], v13 offset:16384
    v_mfma_f32_16x16x32_bf16 v[68:71], a[168:171], v[36:39], v[68:71]
    buffer_load_dwordx4 v5, s[16:19], m0 offen offset:1024 sc1 lds
    v_mfma_f32_16x16x32_bf16 v[84:87], a[172:175], v[36:39], v[84:87]
    s_waitcnt lgkmcnt(3)
    v_mfma_f32_16x16x32_bf16 v[100:103], a[176:179], v[36:39], v[100:103]
    ds_read_b128 v[36:39], v13 offset:36864
    v_mfma_f32_16x16x32_bf16 v[56:59], a[180:183], v[40:43], v[56:59]
    v_mfma_f32_16x16x32_bf16 v[72:75], a[184:187], v[40:43], v[72:75]
    v_mfma_f32_16x16x32_bf16 v[88:91], a[188:191], v[40:43], v[88:91]
    ds_read_b128 v[40:43], v12 offset:17408
    v_mfma_f32_16x16x32_bf16 v[60:63], a[180:183], v[44:47], v[60:63]
    buffer_load_dwordx4 v5, s[16:19], m0 offen offset:2048 sc1 lds
    v_mfma_f32_16x16x32_bf16 v[76:79], a[184:187], v[44:47], v[76:79]
    v_mfma_f32_16x16x32_bf16 v[92:95], a[188:191], v[44:47], v[92:95]
    ds_read_b128 v[44:47], v12 offset:37888
    v_mfma_f32_16x16x32_bf16 v[64:67], a[180:183], v[48:51], v[64:67]
    v_mfma_f32_16x16x32_bf16 v[80:83], a[184:187], v[48:51], v[80:83]
    buffer_load_dwordx4 v5, s[16:19], m0 offen offset:3072 sc1 lds
    v_mfma_f32_16x16x32_bf16 v[96:99], a[188:191], v[48:51], v[96:99]
    ds_read_b128 v[48:51], v13 offset:17408
    v_mfma_f32_16x16x32_bf16 v[68:71], a[180:183], v[52:55], v[68:71]
    s_add_u32 m0, s53, 16384
    v_mfma_f32_16x16x32_bf16 v[84:87], a[184:187], v[52:55], v[84:87]
    s_waitcnt lgkmcnt(3)
    v_mfma_f32_16x16x32_bf16 v[100:103], a[188:191], v[52:55], v[100:103]
    ds_read_b128 v[52:55], v13 offset:37888
    v_mfma_f32_16x16x32_bf16 v[56:59], a[192:195], v[24:27], v[56:59]
    buffer_load_dwordx4 v5, s[16:19], m0 offen offset:0 sc1 lds
    v_mfma_f32_16x16x32_bf16 v[72:75], a[196:199], v[24:27], v[72:75]
    v_mfma_f32_16x16x32_bf16 v[88:91], a[200:203], v[24:27], v[88:91]
    ds_read_b128 v[24:27], v12 offset:18432
    v_mfma_f32_16x16x32_bf16 v[60:63], a[192:195], v[28:31], v[60:63]
    v_mfma_f32_16x16x32_bf16 v[76:79], a[196:199], v[28:31], v[76:79]
    buffer_load_dwordx4 v5, s[16:19], m0 offen offset:1024 sc1 lds
    v_mfma_f32_16x16x32_bf16 v[92:95], a[200:203], v[28:31], v[92:95]
    ds_read_b128 v[28:31], v12 offset:38912
    v_mfma_f32_16x16x32_bf16 v[64:67], a[192:195], v[32:35], v[64:67]
    v_mfma_f32_16x16x32_bf16 v[80:83], a[196:199], v[32:35], v[80:83]
    v_mfma_f32_16x16x32_bf16 v[96:99], a[200:203], v[32:35], v[96:99]
    ds_read_b128 v[32:35], v13 offset:18432
    v_mfma_f32_16x16x32_bf16 v[68:71], a[192:195], v[36:39], v[68:71]
    buffer_load_dwordx4 v5, s[16:19], m0 offen offset:2048 sc1 lds
    v_mfma_f32_16x16x32_bf16 v[84:87], a[196:199], v[36:39], v[84:87]
    s_waitcnt lgkmcnt(3)
    v_mfma_f32_16x16x32_bf16 v[100:103], a[200:203], v[36:39], v[100:103]
    ds_read_b128 v[36:39], v13 offset:38912
    v_mfma_f32_16x16x32_bf16 v[56:59], a[204:207], v[40:43], v[56:59]
    v_mfma_f32_16x16x32_bf16 v[72:75], a[208:211], v[40:43], v[72:75]
    v_mfma_f32_16x16x32_bf16 v[88:91], a[212:215], v[40:43], v[88:91]
    ds_read_b128 v[40:43], v12 offset:19456
    v_mfma_f32_16x16x32_bf16 v[60:63], a[204:207], v[44:47], v[60:63]
    buffer_load_dwordx4 v5, s[16:19], m0 offen offset:3072 sc1 lds
    v_mfma_f32_16x16x32_bf16 v[76:79], a[208:211], v[44:47], v[76:79]
    v_mfma_f32_16x16x32_bf16 v[92:95], a[212:215], v[44:47], v[92:95]
    ds_read_b128 v[44:47], v12 offset:39936
    v_mfma_f32_16x16x32_bf16 v[64:67], a[204:207], v[48:51], v[64:67]
    v_mfma_f32_16x16x32_bf16 v[80:83], a[208:211], v[48:51], v[80:83]
    buffer_load_dwordx4 v[164:167], v20, s[12:15], s30 offen offset:0 sc1
    v_mfma_f32_16x16x32_bf16 v[96:99], a[212:215], v[48:51], v[96:99]
    ds_read_b128 v[48:51], v13 offset:19456
    v_mfma_f32_16x16x32_bf16 v[68:71], a[204:207], v[52:55], v[68:71]
    v_mfma_f32_16x16x32_bf16 v[84:87], a[208:211], v[52:55], v[84:87]
    s_waitcnt lgkmcnt(3)
    v_mfma_f32_16x16x32_bf16 v[100:103], a[212:215], v[52:55], v[100:103]
    ds_read_b128 v[52:55], v13 offset:39936
    s_waitcnt vmcnt(13)
    s_barrier
    v_add_u32 v12, 40960, v12
    v_add_u32 v13, 40960, v13
    v_mfma_f32_16x16x32_bf16 v[56:59], a[216:219], v[24:27], v[56:59]
    buffer_load_dwordx4 v[168:171], v20, s[12:15], s30 offen offset:16 sc1
    v_mfma_f32_16x16x32_bf16 v[72:75], a[220:223], v[24:27], v[72:75]
    v_mfma_f32_16x16x32_bf16 v[88:91], a[224:227], v[24:27], v[88:91]
    ds_read_b128 v[24:27], v12 offset:0
    v_mfma_f32_16x16x32_bf16 v[60:63], a[216:219], v[28:31], v[60:63]
    v_mfma_f32_16x16x32_bf16 v[76:79], a[220:223], v[28:31], v[76:79]
    buffer_load_dwordx4 v[188:191], v14, s[12:15], 0 offen offset:0 sc1
    v_mfma_f32_16x16x32_bf16 v[92:95], a[224:227], v[28:31], v[92:95]
    ds_read_b128 v[28:31], v12 offset:20480
    v_mfma_f32_16x16x32_bf16 v[64:67], a[216:219], v[32:35], v[64:67]
    v_mfma_f32_16x16x32_bf16 v[80:83], a[220:223], v[32:35], v[80:83]
    v_mfma_f32_16x16x32_bf16 v[96:99], a[224:227], v[32:35], v[96:99]
    ds_read_b128 v[32:35], v13 offset:0
    v_mfma_f32_16x16x32_bf16 v[68:71], a[216:219], v[36:39], v[68:71]
    buffer_load_dwordx4 v[192:195], v14, s[12:15], 0 offen offset:1024 sc1
    v_mfma_f32_16x16x32_bf16 v[84:87], a[220:223], v[36:39], v[84:87]
    s_waitcnt lgkmcnt(3)
    v_mfma_f32_16x16x32_bf16 v[100:103], a[224:227], v[36:39], v[100:103]
    ds_read_b128 v[36:39], v13 offset:20480
    v_mfma_f32_16x16x32_bf16 v[56:59], a[228:231], v[40:43], v[56:59]
    v_mfma_f32_16x16x32_bf16 v[72:75], a[232:235], v[40:43], v[72:75]
    v_mfma_f32_16x16x32_bf16 v[88:91], a[236:239], v[40:43], v[88:91]
    ds_read_b128 v[40:43], v12 offset:1024
    v_mfma_f32_16x16x32_bf16 v[60:63], a[228:231], v[44:47], v[60:63]
    buffer_load_dwordx4 v[196:199], v14, s[12:15], 0 offen offset:2048 sc1
    v_mfma_f32_16x16x32_bf16 v[76:79], a[232:235], v[44:47], v[76:79]
    v_mfma_f32_16x16x32_bf16 v[92:95], a[236:239], v[44:47], v[92:95]
    ds_read_b128 v[44:47], v12 offset:21504
    v_mfma_f32_16x16x32_bf16 v[64:67], a[228:231], v[48:51], v[64:67]
    v_mfma_f32_16x16x32_bf16 v[80:83], a[232:235], v[48:51], v[80:83]
    buffer_load_dwordx4 v[200:203], v14, s[12:15], 0 offen offset:3072 sc1
    v_mfma_f32_16x16x32_bf16 v[96:99], a[236:239], v[48:51], v[96:99]
    ds_read_b128 v[48:51], v13 offset:1024
    v_mfma_f32_16x16x32_bf16 v[68:71], a[228:231], v[52:55], v[68:71]
    v_add_u32 v14, 0x1000, v14
    v_mfma_f32_16x16x32_bf16 v[84:87], a[232:235], v[52:55], v[84:87]
    s_waitcnt lgkmcnt(3)
    v_mfma_f32_16x16x32_bf16 v[100:103], a[236:239], v[52:55], v[100:103]
    ds_read_b128 v[52:55], v13 offset:21504
    v_mfma_f32_16x16x32_bf16 v[104:107], a[0:3], v[24:27], 0
    buffer_load_dwordx4 v[204:207], v14, s[12:15], 0 offen offset:0 sc1
    v_mfma_f32_16x16x32_bf16 v[120:123], a[4:7], v[24:27], 0
    v_mfma_f32_16x16x32_bf16 v[136:139], a[8:11], v[24:27], 0
    ds_read_b128 v[24:27], v12 offset:2048
    v_mfma_f32_16x16x32_bf16 v[108:111], a[0:3], v[28:31], 0
    v_mfma_f32_16x16x32_bf16 v[124:127], a[4:7], v[28:31], 0
    buffer_load_dwordx4 v[208:211], v14, s[12:15], 0 offen offset:1024 sc1
    v_mfma_f32_16x16x32_bf16 v[140:143], a[8:11], v[28:31], 0
    ds_read_b128 v[28:31], v12 offset:22528
    v_mfma_f32_16x16x32_bf16 v[112:115], a[0:3], v[32:35], 0
    v_mfma_f32_16x16x32_bf16 v[128:131], a[4:7], v[32:35], 0
    v_mfma_f32_16x16x32_bf16 v[144:147], a[8:11], v[32:35], 0
    ds_read_b128 v[32:35], v13 offset:2048
    v_mfma_f32_16x16x32_bf16 v[116:119], a[0:3], v[36:39], 0
    buffer_load_dwordx4 v[212:215], v14, s[12:15], 0 offen offset:2048 sc1
    v_mfma_f32_16x16x32_bf16 v[132:135], a[4:7], v[36:39], 0
    s_waitcnt lgkmcnt(3)
    v_mfma_f32_16x16x32_bf16 v[148:151], a[8:11], v[36:39], 0
    ds_read_b128 v[36:39], v13 offset:22528
    v_pk_mul_f32 v[56:57], v[56:57], v[72:73]
    v_pk_mul_f32 v[58:59], v[58:59], v[74:75]
    v_pk_mul_f32 v[60:61], v[60:61], v[76:77]
    v_pk_mul_f32 v[62:63], v[62:63], v[78:79]
    v_permlane32_swap_b32 v88, v92
    v_permlane32_swap_b32 v89, v93
    v_permlane32_swap_b32 v90, v94
    v_permlane32_swap_b32 v91, v95
    v_cvt_pk_bf16_f32 v152, v56, v57
    v_cvt_pk_bf16_f32 v153, v58, v59
    v_cvt_pk_bf16_f32 v154, v60, v61
    v_cvt_pk_bf16_f32 v155, v62, v63
    v_pk_mul_f32 v[88:89], v[88:89], v[92:93]
    v_pk_mul_f32 v[90:91], v[90:91], v[94:95]
    v_permlane16_swap_b32 v152, v154
    v_permlane16_swap_b32 v153, v155
    v_cvt_pk_bf16_f32 v160, v88, v89
    v_cvt_pk_bf16_f32 v161, v90, v91
    buffer_store_dwordx4 v[152:155], v9, s[12:15], s58 offen sc1
    v_pk_mul_f32 v[64:65], v[64:65], v[80:81]
    v_pk_mul_f32 v[66:67], v[66:67], v[82:83]
    v_pk_mul_f32 v[68:69], v[68:69], v[84:85]
    v_pk_mul_f32 v[70:71], v[70:71], v[86:87]
    v_permlane32_swap_b32 v96, v100
    v_permlane32_swap_b32 v97, v101
    v_permlane32_swap_b32 v98, v102
    v_permlane32_swap_b32 v99, v103
    v_cvt_pk_bf16_f32 v156, v64, v65
    v_cvt_pk_bf16_f32 v157, v66, v67
    v_cvt_pk_bf16_f32 v158, v68, v69
    v_cvt_pk_bf16_f32 v159, v70, v71
    v_pk_mul_f32 v[96:97], v[96:97], v[100:101]
    v_pk_mul_f32 v[98:99], v[98:99], v[102:103]
    v_permlane16_swap_b32 v156, v158
    v_permlane16_swap_b32 v157, v159
    v_cvt_pk_bf16_f32 v162, v96, v97
    v_cvt_pk_bf16_f32 v163, v98, v99
    buffer_store_dwordx4 v[156:159], v9, s[12:15], s60 offen sc1
    v_permlane16_swap_b32 v160, v162
    v_permlane16_swap_b32 v161, v163
    buffer_store_dwordx4 v[160:163], v10, s[12:15], s58 offen offset:512 sc1
    v_mfma_f32_16x16x32_bf16 v[104:107], a[12:15], v[40:43], v[104:107]
    v_mfma_f32_16x16x32_bf16 v[120:123], a[16:19], v[40:43], v[120:123]
    v_mfma_f32_16x16x32_bf16 v[136:139], a[20:23], v[40:43], v[136:139]
    ds_read_b128 v[40:43], v12 offset:3072
    v_mfma_f32_16x16x32_bf16 v[108:111], a[12:15], v[44:47], v[108:111]
    buffer_load_dwordx4 v[216:219], v14, s[12:15], 0 offen offset:3072 sc1
    v_mfma_f32_16x16x32_bf16 v[124:127], a[16:19], v[44:47], v[124:127]
    v_add_u32 v14, 0x1000, v14
    v_mfma_f32_16x16x32_bf16 v[140:143], a[20:23], v[44:47], v[140:143]
    ds_read_b128 v[44:47], v12 offset:23552
    v_mfma_f32_16x16x32_bf16 v[112:115], a[12:15], v[48:51], v[112:115]
    v_mfma_f32_16x16x32_bf16 v[128:131], a[16:19], v[48:51], v[128:131]
    buffer_load_dwordx4 v[220:223], v14, s[12:15], 0 offen offset:0 sc1
    v_mfma_f32_16x16x32_bf16 v[144:147], a[20:23], v[48:51], v[144:147]
    ds_read_b128 v[48:51], v13 offset:3072
    v_mfma_f32_16x16x32_bf16 v[116:119], a[12:15], v[52:55], v[116:119]
    v_mfma_f32_16x16x32_bf16 v[132:135], a[16:19], v[52:55], v[132:135]
    s_waitcnt lgkmcnt(3)
    v_mfma_f32_16x16x32_bf16 v[148:151], a[20:23], v[52:55], v[148:151]
    ds_read_b128 v[52:55], v13 offset:23552
    v_mfma_f32_16x16x32_bf16 v[104:107], a[24:27], v[24:27], v[104:107]
    buffer_load_dwordx4 v[224:227], v14, s[12:15], 0 offen offset:1024 sc1
    v_mfma_f32_16x16x32_bf16 v[120:123], a[28:31], v[24:27], v[120:123]
    v_mfma_f32_16x16x32_bf16 v[136:139], a[32:35], v[24:27], v[136:139]
    ds_read_b128 v[24:27], v12 offset:4096
    v_mfma_f32_16x16x32_bf16 v[108:111], a[24:27], v[28:31], v[108:111]
    v_mfma_f32_16x16x32_bf16 v[124:127], a[28:31], v[28:31], v[124:127]
    buffer_load_dwordx4 v[228:231], v14, s[12:15], 0 offen offset:2048 sc1
    v_mfma_f32_16x16x32_bf16 v[140:143], a[32:35], v[28:31], v[140:143]
    ds_read_b128 v[28:31], v12 offset:24576
    v_mfma_f32_16x16x32_bf16 v[112:115], a[24:27], v[32:35], v[112:115]
    v_mfma_f32_16x16x32_bf16 v[128:131], a[28:31], v[32:35], v[128:131]
    v_mfma_f32_16x16x32_bf16 v[144:147], a[32:35], v[32:35], v[144:147]
    ds_read_b128 v[32:35], v13 offset:4096
    v_mfma_f32_16x16x32_bf16 v[116:119], a[24:27], v[36:39], v[116:119]
    buffer_load_dwordx4 v[232:235], v14, s[12:15], 0 offen offset:3072 sc1
    v_mfma_f32_16x16x32_bf16 v[132:135], a[28:31], v[36:39], v[132:135]
    s_waitcnt lgkmcnt(3)
    v_mfma_f32_16x16x32_bf16 v[148:151], a[32:35], v[36:39], v[148:151]
    ds_read_b128 v[36:39], v13 offset:24576
    v_mfma_f32_16x16x32_bf16 v[104:107], a[36:39], v[40:43], v[104:107]
    v_add_u32 v14, 0x1000, v14
    v_mfma_f32_16x16x32_bf16 v[120:123], a[40:43], v[40:43], v[120:123]
    v_mfma_f32_16x16x32_bf16 v[136:139], a[44:47], v[40:43], v[136:139]
    ds_read_b128 v[40:43], v12 offset:5120
    v_mfma_f32_16x16x32_bf16 v[108:111], a[36:39], v[44:47], v[108:111]
    buffer_load_dwordx4 v[236:239], v14, s[12:15], 0 offen offset:0 sc1
    v_mfma_f32_16x16x32_bf16 v[124:127], a[40:43], v[44:47], v[124:127]
    v_mfma_f32_16x16x32_bf16 v[140:143], a[44:47], v[44:47], v[140:143]
    ds_read_b128 v[44:47], v12 offset:25600
    v_mfma_f32_16x16x32_bf16 v[112:115], a[36:39], v[48:51], v[112:115]
    v_mfma_f32_16x16x32_bf16 v[128:131], a[40:43], v[48:51], v[128:131]
    buffer_load_dwordx4 v[240:243], v14, s[12:15], 0 offen offset:1024 sc1
    v_mfma_f32_16x16x32_bf16 v[144:147], a[44:47], v[48:51], v[144:147]
    ds_read_b128 v[48:51], v13 offset:5120
    v_mfma_f32_16x16x32_bf16 v[116:119], a[36:39], v[52:55], v[116:119]
    v_mfma_f32_16x16x32_bf16 v[132:135], a[40:43], v[52:55], v[132:135]
    s_waitcnt lgkmcnt(3)
    v_mfma_f32_16x16x32_bf16 v[148:151], a[44:47], v[52:55], v[148:151]
    ds_read_b128 v[52:55], v13 offset:25600
    v_mfma_f32_16x16x32_bf16 v[104:107], a[48:51], v[24:27], v[104:107]
    buffer_load_dwordx4 v[244:247], v14, s[12:15], 0 offen offset:2048 sc1
    v_mfma_f32_16x16x32_bf16 v[120:123], a[52:55], v[24:27], v[120:123]
    v_mfma_f32_16x16x32_bf16 v[136:139], a[56:59], v[24:27], v[136:139]
    ds_read_b128 v[24:27], v12 offset:6144
    v_mfma_f32_16x16x32_bf16 v[108:111], a[48:51], v[28:31], v[108:111]
    v_mfma_f32_16x16x32_bf16 v[124:127], a[52:55], v[28:31], v[124:127]
    buffer_load_dwordx4 v[248:251], v14, s[12:15], 0 offen offset:3072 sc1
    v_mfma_f32_16x16x32_bf16 v[140:143], a[56:59], v[28:31], v[140:143]
    ds_read_b128 v[28:31], v12 offset:26624
    v_mfma_f32_16x16x32_bf16 v[112:115], a[48:51], v[32:35], v[112:115]
    v_add_u32 v14, 0x1000, v14
    v_mfma_f32_16x16x32_bf16 v[128:131], a[52:55], v[32:35], v[128:131]
    v_mfma_f32_16x16x32_bf16 v[144:147], a[56:59], v[32:35], v[144:147]
    ds_read_b128 v[32:35], v13 offset:6144
    v_mfma_f32_16x16x32_bf16 v[116:119], a[48:51], v[36:39], v[116:119]
    buffer_load_dwordx4 v[252:255], v14, s[12:15], 0 offen offset:0 sc1
    v_mfma_f32_16x16x32_bf16 v[132:135], a[52:55], v[36:39], v[132:135]
    s_waitcnt lgkmcnt(3)
    v_mfma_f32_16x16x32_bf16 v[148:151], a[56:59], v[36:39], v[148:151]
    ds_read_b128 v[36:39], v13 offset:26624
    v_mfma_f32_16x16x32_bf16 v[104:107], a[60:63], v[40:43], v[104:107]
    v_mfma_f32_16x16x32_bf16 v[120:123], a[64:67], v[40:43], v[120:123]
    v_mfma_f32_16x16x32_bf16 v[136:139], a[68:71], v[40:43], v[136:139]
    ds_read_b128 v[40:43], v12 offset:7168
    v_mfma_f32_16x16x32_bf16 v[108:111], a[60:63], v[44:47], v[108:111]
    buffer_load_dwordx4 a[0:3], v14, s[12:15], 0 offen offset:1024 sc1
    v_mfma_f32_16x16x32_bf16 v[124:127], a[64:67], v[44:47], v[124:127]
    v_mfma_f32_16x16x32_bf16 v[140:143], a[68:71], v[44:47], v[140:143]
    ds_read_b128 v[44:47], v12 offset:27648
    v_mfma_f32_16x16x32_bf16 v[112:115], a[60:63], v[48:51], v[112:115]
    v_mfma_f32_16x16x32_bf16 v[128:131], a[64:67], v[48:51], v[128:131]
    buffer_load_dwordx4 a[4:7], v14, s[12:15], 0 offen offset:2048 sc1
    v_mfma_f32_16x16x32_bf16 v[144:147], a[68:71], v[48:51], v[144:147]
    ds_read_b128 v[48:51], v13 offset:7168
    v_mfma_f32_16x16x32_bf16 v[116:119], a[60:63], v[52:55], v[116:119]
    v_mfma_f32_16x16x32_bf16 v[132:135], a[64:67], v[52:55], v[132:135]
    s_waitcnt lgkmcnt(3)
    v_mfma_f32_16x16x32_bf16 v[148:151], a[68:71], v[52:55], v[148:151]
    ds_read_b128 v[52:55], v13 offset:27648
    s_waitcnt vmcnt(24)
    s_barrier
    v_mfma_f32_16x16x32_bf16 v[104:107], a[72:75], v[24:27], v[104:107]
    buffer_load_dwordx4 a[8:11], v14, s[12:15], 0 offen offset:3072 sc1
    v_mfma_f32_16x16x32_bf16 v[120:123], a[76:79], v[24:27], v[120:123]
    v_add_u32 v14, 0x1000, v14
    v_mfma_f32_16x16x32_bf16 v[136:139], a[80:83], v[24:27], v[136:139]
    ds_read_b128 v[24:27], v12 offset:8192
    v_mfma_f32_16x16x32_bf16 v[108:111], a[72:75], v[28:31], v[108:111]
    v_mfma_f32_16x16x32_bf16 v[124:127], a[76:79], v[28:31], v[124:127]
    buffer_load_dwordx4 a[12:15], v14, s[12:15], 0 offen offset:0 sc1
    v_mfma_f32_16x16x32_bf16 v[140:143], a[80:83], v[28:31], v[140:143]
    ds_read_b128 v[28:31], v12 offset:28672
    v_mfma_f32_16x16x32_bf16 v[112:115], a[72:75], v[32:35], v[112:115]
    v_mfma_f32_16x16x32_bf16 v[128:131], a[76:79], v[32:35], v[128:131]
    v_mfma_f32_16x16x32_bf16 v[144:147], a[80:83], v[32:35], v[144:147]
    ds_read_b128 v[32:35], v13 offset:8192
    v_mfma_f32_16x16x32_bf16 v[116:119], a[72:75], v[36:39], v[116:119]
    buffer_load_dwordx4 a[16:19], v14, s[12:15], 0 offen offset:1024 sc1
    v_mfma_f32_16x16x32_bf16 v[132:135], a[76:79], v[36:39], v[132:135]
    s_waitcnt lgkmcnt(3)
    v_mfma_f32_16x16x32_bf16 v[148:151], a[80:83], v[36:39], v[148:151]
    ds_read_b128 v[36:39], v13 offset:28672
    v_mfma_f32_16x16x32_bf16 v[104:107], a[84:87], v[40:43], v[104:107]
    v_mfma_f32_16x16x32_bf16 v[120:123], a[88:91], v[40:43], v[120:123]
    v_mfma_f32_16x16x32_bf16 v[136:139], a[92:95], v[40:43], v[136:139]
    ds_read_b128 v[40:43], v12 offset:9216
    v_mfma_f32_16x16x32_bf16 v[108:111], a[84:87], v[44:47], v[108:111]
    buffer_load_dwordx4 a[20:23], v14, s[12:15], 0 offen offset:2048 sc1
    v_mfma_f32_16x16x32_bf16 v[124:127], a[88:91], v[44:47], v[124:127]
    v_mfma_f32_16x16x32_bf16 v[140:143], a[92:95], v[44:47], v[140:143]
    ds_read_b128 v[44:47], v12 offset:29696
    v_mfma_f32_16x16x32_bf16 v[112:115], a[84:87], v[48:51], v[112:115]
    v_mfma_f32_16x16x32_bf16 v[128:131], a[88:91], v[48:51], v[128:131]
    buffer_load_dwordx4 a[24:27], v14, s[12:15], 0 offen offset:3072 sc1
    v_mfma_f32_16x16x32_bf16 v[144:147], a[92:95], v[48:51], v[144:147]
    ds_read_b128 v[48:51], v13 offset:9216
    v_mfma_f32_16x16x32_bf16 v[116:119], a[84:87], v[52:55], v[116:119]
    v_add_u32 v14, 0x1000, v14
    v_mfma_f32_16x16x32_bf16 v[132:135], a[88:91], v[52:55], v[132:135]
    s_waitcnt lgkmcnt(3)
    v_mfma_f32_16x16x32_bf16 v[148:151], a[92:95], v[52:55], v[148:151]
    ds_read_b128 v[52:55], v13 offset:29696
    v_mfma_f32_16x16x32_bf16 v[104:107], a[96:99], v[24:27], v[104:107]
    buffer_load_dwordx4 a[28:31], v14, s[12:15], 0 offen offset:0 sc1
    v_mfma_f32_16x16x32_bf16 v[120:123], a[100:103], v[24:27], v[120:123]
    v_mfma_f32_16x16x32_bf16 v[136:139], a[104:107], v[24:27], v[136:139]
    ds_read_b128 v[24:27], v12 offset:10240
    v_mfma_f32_16x16x32_bf16 v[108:111], a[96:99], v[28:31], v[108:111]
    v_mfma_f32_16x16x32_bf16 v[124:127], a[100:103], v[28:31], v[124:127]
    buffer_load_dwordx4 a[32:35], v14, s[12:15], 0 offen offset:1024 sc1
    v_mfma_f32_16x16x32_bf16 v[140:143], a[104:107], v[28:31], v[140:143]
    ds_read_b128 v[28:31], v12 offset:30720
    v_mfma_f32_16x16x32_bf16 v[112:115], a[96:99], v[32:35], v[112:115]
    v_mfma_f32_16x16x32_bf16 v[128:131], a[100:103], v[32:35], v[128:131]
    v_mfma_f32_16x16x32_bf16 v[144:147], a[104:107], v[32:35], v[144:147]
    ds_read_b128 v[32:35], v13 offset:10240
    v_mfma_f32_16x16x32_bf16 v[116:119], a[96:99], v[36:39], v[116:119]
    buffer_load_dwordx4 a[36:39], v14, s[12:15], 0 offen offset:2048 sc1
    v_mfma_f32_16x16x32_bf16 v[132:135], a[100:103], v[36:39], v[132:135]
    s_waitcnt lgkmcnt(3)
    v_mfma_f32_16x16x32_bf16 v[148:151], a[104:107], v[36:39], v[148:151]
    ds_read_b128 v[36:39], v13 offset:30720
    s_waitcnt vmcnt(20)
    s_barrier
    s_cmp_lg_u32 s22, 0
    s_cbranch_scc1 LHA_sig
    s_mov_b64 exec, 1
    buffer_atomic_add v3, v2, s[12:15], s55 offen sc1
    s_mov_b64 exec, -1
LHA_sig:
    v_mfma_f32_16x16x32_bf16 v[104:107], a[108:111], v[40:43], v[104:107]
    v_mfma_f32_16x16x32_bf16 v[120:123], a[112:115], v[40:43], v[120:123]
    v_mfma_f32_16x16x32_bf16 v[136:139], a[116:119], v[40:43], v[136:139]
    ds_read_b128 v[40:43], v12 offset:11264
    v_mfma_f32_16x16x32_bf16 v[108:111], a[108:111], v[44:47], v[108:111]
    buffer_load_dwordx4 a[40:43], v14, s[12:15], 0 offen offset:3072 sc1
    v_mfma_f32_16x16x32_bf16 v[124:127], a[112:115], v[44:47], v[124:127]
    v_add_u32 v14, 0x1000, v14
    v_mfma_f32_16x16x32_bf16 v[140:143], a[116:119], v[44:47], v[140:143]
    ds_read_b128 v[44:47], v12 offset:31744
    v_mfma_f32_16x16x32_bf16 v[112:115], a[108:111], v[48:51], v[112:115]
    v_mfma_f32_16x16x32_bf16 v[128:131], a[112:115], v[48:51], v[128:131]
    buffer_load_dwordx4 a[44:47], v14, s[12:15], 0 offen offset:0 sc1
    v_mfma_f32_16x16x32_bf16 v[144:147], a[116:119], v[48:51], v[144:147]
    ds_read_b128 v[48:51], v13 offset:11264
    v_mfma_f32_16x16x32_bf16 v[116:119], a[108:111], v[52:55], v[116:119]
    v_mfma_f32_16x16x32_bf16 v[132:135], a[112:115], v[52:55], v[132:135]
    s_waitcnt lgkmcnt(3)
    v_mfma_f32_16x16x32_bf16 v[148:151], a[116:119], v[52:55], v[148:151]
    ds_read_b128 v[52:55], v13 offset:31744
    v_mfma_f32_16x16x32_bf16 v[104:107], a[120:123], v[24:27], v[104:107]
    buffer_load_dwordx4 a[48:51], v14, s[12:15], 0 offen offset:1024 sc1
    v_mfma_f32_16x16x32_bf16 v[120:123], a[124:127], v[24:27], v[120:123]
    v_mfma_f32_16x16x32_bf16 v[136:139], a[128:131], v[24:27], v[136:139]
    ds_read_b128 v[24:27], v12 offset:12288
    v_mfma_f32_16x16x32_bf16 v[108:111], a[120:123], v[28:31], v[108:111]
    v_mfma_f32_16x16x32_bf16 v[124:127], a[124:127], v[28:31], v[124:127]
    buffer_load_dwordx4 a[52:55], v14, s[12:15], 0 offen offset:2048 sc1
    v_mfma_f32_16x16x32_bf16 v[140:143], a[128:131], v[28:31], v[140:143]
    ds_read_b128 v[28:31], v12 offset:32768
    v_mfma_f32_16x16x32_bf16 v[112:115], a[120:123], v[32:35], v[112:115]
    v_mfma_f32_16x16x32_bf16 v[128:131], a[124:127], v[32:35], v[128:131]
    v_mfma_f32_16x16x32_bf16 v[144:147], a[128:131], v[32:35], v[144:147]
    ds_read_b128 v[32:35], v13 offset:12288
    v_mfma_f32_16x16x32_bf16 v[116:119], a[120:123], v[36:39], v[116:119]
    buffer_load_dwordx4 a[56:59], v14, s[12:15], 0 offen offset:3072 sc1
    v_mfma_f32_16x16x32_bf16 v[132:135], a[124:127], v[36:39], v[132:135]
    s_waitcnt lgkmcnt(3)
    v_mfma_f32_16x16x32_bf16 v[148:151], a[128:131], v[36:39], v[148:151]
    ds_read_b128 v[36:39], v13 offset:32768
    v_mfma_f32_16x16x32_bf16 v[104:107], a[132:135], v[40:43], v[104:107]
    v_add_u32 v14, 0x1000, v14
    v_mfma_f32_16x16x32_bf16 v[120:123], a[136:139], v[40:43], v[120:123]
    v_mfma_f32_16x16x32_bf16 v[136:139], a[140:143], v[40:43], v[136:139]
    ds_read_b128 v[40:43], v12 offset:13312
    v_mfma_f32_16x16x32_bf16 v[108:111], a[132:135], v[44:47], v[108:111]
    buffer_load_dwordx4 a[60:63], v14, s[12:15], 0 offen offset:0 sc1
    v_mfma_f32_16x16x32_bf16 v[124:127], a[136:139], v[44:47], v[124:127]
    v_mfma_f32_16x16x32_bf16 v[140:143], a[140:143], v[44:47], v[140:143]
    ds_read_b128 v[44:47], v12 offset:33792
    v_mfma_f32_16x16x32_bf16 v[112:115], a[132:135], v[48:51], v[112:115]
    v_mfma_f32_16x16x32_bf16 v[128:131], a[136:139], v[48:51], v[128:131]
    buffer_load_dwordx4 a[64:67], v14, s[12:15], 0 offen offset:1024 sc1
    v_mfma_f32_16x16x32_bf16 v[144:147], a[140:143], v[48:51], v[144:147]
    ds_read_b128 v[48:51], v13 offset:13312
    v_mfma_f32_16x16x32_bf16 v[116:119], a[132:135], v[52:55], v[116:119]
    v_mfma_f32_16x16x32_bf16 v[132:135], a[136:139], v[52:55], v[132:135]
    s_waitcnt lgkmcnt(3)
    v_mfma_f32_16x16x32_bf16 v[148:151], a[140:143], v[52:55], v[148:151]
    ds_read_b128 v[52:55], v13 offset:33792
    v_mfma_f32_16x16x32_bf16 v[104:107], a[144:147], v[24:27], v[104:107]
    buffer_load_dwordx4 a[68:71], v14, s[12:15], 0 offen offset:2048 sc1
    v_mfma_f32_16x16x32_bf16 v[120:123], a[148:151], v[24:27], v[120:123]
    v_mfma_f32_16x16x32_bf16 v[136:139], a[152:155], v[24:27], v[136:139]
    ds_read_b128 v[24:27], v12 offset:14336
    v_mfma_f32_16x16x32_bf16 v[108:111], a[144:147], v[28:31], v[108:111]
    v_mfma_f32_16x16x32_bf16 v[124:127], a[148:151], v[28:31], v[124:127]
    buffer_load_dwordx4 a[72:75], v14, s[12:15], 0 offen offset:3072 sc1
    v_mfma_f32_16x16x32_bf16 v[140:143], a[152:155], v[28:31], v[140:143]
    ds_read_b128 v[28:31], v12 offset:34816
    v_mfma_f32_16x16x32_bf16 v[112:115], a[144:147], v[32:35], v[112:115]
    v_add_u32 v14, 0x1000, v14
    v_mfma_f32_16x16x32_bf16 v[128:131], a[148:151], v[32:35], v[128:131]
    v_mfma_f32_16x16x32_bf16 v[144:147], a[152:155], v[32:35], v[144:147]
    ds_read_b128 v[32:35], v13 offset:14336
    v_mfma_f32_16x16x32_bf16 v[116:119], a[144:147], v[36:39], v[116:119]
    buffer_load_dwordx4 a[76:79], v14, s[12:15], 0 offen offset:0 sc1
    v_mfma_f32_16x16x32_bf16 v[132:135], a[148:151], v[36:39], v[132:135]
    s_waitcnt lgkmcnt(3)
    v_mfma_f32_16x16x32_bf16 v[148:151], a[152:155], v[36:39], v[148:151]
    ds_read_b128 v[36:39], v13 offset:34816
    v_mfma_f32_16x16x32_bf16 v[104:107], a[156:159], v[40:43], v[104:107]
    v_mfma_f32_16x16x32_bf16 v[120:123], a[160:163], v[40:43], v[120:123]
    v_mfma_f32_16x16x32_bf16 v[136:139], a[164:167], v[40:43], v[136:139]
    ds_read_b128 v[40:43], v12 offset:15360
    v_mfma_f32_16x16x32_bf16 v[108:111], a[156:159], v[44:47], v[108:111]
    buffer_load_dwordx4 a[80:83], v14, s[12:15], 0 offen offset:1024 sc1
    v_mfma_f32_16x16x32_bf16 v[124:127], a[160:163], v[44:47], v[124:127]
    v_mfma_f32_16x16x32_bf16 v[140:143], a[164:167], v[44:47], v[140:143]
    ds_read_b128 v[44:47], v12 offset:35840
    v_mfma_f32_16x16x32_bf16 v[112:115], a[156:159], v[48:51], v[112:115]
    v_mfma_f32_16x16x32_bf16 v[128:131], a[160:163], v[48:51], v[128:131]
    buffer_load_dwordx4 a[84:87], v14, s[12:15], 0 offen offset:2048 sc1
    v_mfma_f32_16x16x32_bf16 v[144:147], a[164:167], v[48:51], v[144:147]
    ds_read_b128 v[48:51], v13 offset:15360
    v_mfma_f32_16x16x32_bf16 v[116:119], a[156:159], v[52:55], v[116:119]
    v_mfma_f32_16x16x32_bf16 v[132:135], a[160:163], v[52:55], v[132:135]
    s_waitcnt lgkmcnt(3)
    v_mfma_f32_16x16x32_bf16 v[148:151], a[164:167], v[52:55], v[148:151]
    ds_read_b128 v[52:55], v13 offset:35840
    buffer_load_dword v11, v2, s[12:15], s55 offen sc1
    v_mfma_f32_16x16x32_bf16 v[104:107], a[168:171], v[24:27], v[104:107]
    buffer_load_dwordx4 a[88:91], v14, s[12:15], 0 offen offset:3072 sc1
    v_mfma_f32_16x16x32_bf16 v[120:123], a[172:175], v[24:27], v[120:123]
    v_add_u32 v14, 0x1000, v14
    v_mfma_f32_16x16x32_bf16 v[136:139], a[176:179], v[24:27], v[136:139]
    ds_read_b128 v[24:27], v12 offset:16384
    v_mfma_f32_16x16x32_bf16 v[108:111], a[168:171], v[28:31], v[108:111]
    v_mfma_f32_16x16x32_bf16 v[124:127], a[172:175], v[28:31], v[124:127]
    buffer_load_dwordx4 a[92:95], v14, s[12:15], 0 offen offset:0 sc1
    v_mfma_f32_16x16x32_bf16 v[140:143], a[176:179], v[28:31], v[140:143]
    ds_read_b128 v[28:31], v12 offset:36864
    v_mfma_f32_16x16x32_bf16 v[112:115], a[168:171], v[32:35], v[112:115]
    v_mfma_f32_16x16x32_bf16 v[128:131], a[172:175], v[32:35], v[128:131]
    v_mfma_f32_16x16x32_bf16 v[144:147], a[176:179], v[32:35], v[144:147]
    ds_read_b128 v[32:35], v13 offset:16384
    v_mfma_f32_16x16x32_bf16 v[116:119], a[168:171], v[36:39], v[116:119]
    buffer_load_dwordx4 a[96:99], v14, s[12:15], 0 offen offset:1024 sc1
    v_mfma_f32_16x16x32_bf16 v[132:135], a[172:175], v[36:39], v[132:135]
    s_waitcnt lgkmcnt(3)
    v_mfma_f32_16x16x32_bf16 v[148:151], a[176:179], v[36:39], v[148:151]
    ds_read_b128 v[36:39], v13 offset:36864
    v_mfma_f32_16x16x32_bf16 v[104:107], a[180:183], v[40:43], v[104:107]
    v_mfma_f32_16x16x32_bf16 v[120:123], a[184:187], v[40:43], v[120:123]
    v_mfma_f32_16x16x32_bf16 v[136:139], a[188:191], v[40:43], v[136:139]
    ds_read_b128 v[40:43], v12 offset:17408
    v_mfma_f32_16x16x32_bf16 v[108:111], a[180:183], v[44:47], v[108:111]
    buffer_load_dwordx4 a[100:103], v14, s[12:15], 0 offen offset:2048 sc1
    v_mfma_f32_16x16x32_bf16 v[124:127], a[184:187], v[44:47], v[124:127]
    v_mfma_f32_16x16x32_bf16 v[140:143], a[188:191], v[44:47], v[140:143]
    ds_read_b128 v[44:47], v12 offset:37888
    v_mfma_f32_16x16x32_bf16 v[112:115], a[180:183], v[48:51], v[112:115]
    v_mfma_f32_16x16x32_bf16 v[128:131], a[184:187], v[48:51], v[128:131]
    buffer_load_dwordx4 a[104:107], v14, s[12:15], 0 offen offset:3072 sc1
    v_mfma_f32_16x16x32_bf16 v[144:147], a[188:191], v[48:51], v[144:147]
    ds_read_b128 v[48:51], v13 offset:17408
    v_mfma_f32_16x16x32_bf16 v[116:119], a[180:183], v[52:55], v[116:119]
    v_add_u32 v14, 0x1000, v14
    v_mfma_f32_16x16x32_bf16 v[132:135], a[184:187], v[52:55], v[132:135]
    s_waitcnt lgkmcnt(3)
    v_mfma_f32_16x16x32_bf16 v[148:151], a[188:191], v[52:55], v[148:151]
    ds_read_b128 v[52:55], v13 offset:37888
    v_mfma_f32_16x16x32_bf16 v[104:107], a[192:195], v[24:27], v[104:107]
    buffer_load_dwordx4 a[108:111], v14, s[12:15], 0 offen offset:0 sc1
    v_mfma_f32_16x16x32_bf16 v[120:123], a[196:199], v[24:27], v[120:123]
    v_mfma_f32_16x16x32_bf16 v[136:139], a[200:203], v[24:27], v[136:139]
    ds_read_b128 v[24:27], v12 offset:18432
    v_mfma_f32_16x16x32_bf16 v[108:111], a[192:195], v[28:31], v[108:111]
    v_mfma_f32_16x16x32_bf16 v[124:127], a[196:199], v[28:31], v[124:127]
    buffer_load_dwordx4 a[112:115], v14, s[12:15], 0 offen offset:1024 sc1
    v_mfma_f32_16x16x32_bf16 v[140:143], a[200:203], v[28:31], v[140:143]
    ds_read_b128 v[28:31], v12 offset:38912
    v_mfma_f32_16x16x32_bf16 v[112:115], a[192:195], v[32:35], v[112:115]
    v_mfma_f32_16x16x32_bf16 v[128:131], a[196:199], v[32:35], v[128:131]
    v_mfma_f32_16x16x32_bf16 v[144:147], a[200:203], v[32:35], v[144:147]
    ds_read_b128 v[32:35], v13 offset:18432
    v_mfma_f32_16x16x32_bf16 v[116:119], a[192:195], v[36:39], v[116:119]
    buffer_load_dwordx4 a[116:119], v14, s[12:15], 0 offen offset:2048 sc1
    v_mfma_f32_16x16x32_bf16 v[132:135], a[196:199], v[36:39], v[132:135]
    s_waitcnt lgkmcnt(3)
    v_mfma_f32_16x16x32_bf16 v[148:151], a[200:203], v[36:39], v[148:151]
    ds_read_b128 v[36:39], v13 offset:38912
    s_waitcnt vmcnt(8)
    v_readfirstlane_b32 s33, v11
    s_nop 0
    s_cmp_ge_u32 s33, 16
    s_cbranch_scc0 LHA_spin
LHA_ok:
    v_mfma_f32_16x16x32_bf16 v[104:107], a[204:207], v[40:43], v[104:107]
    v_mfma_f32_16x16x32_bf16 v[120:123], a[208:211], v[40:43], v[120:123]
    v_mfma_f32_16x16x32_bf16 v[136:139], a[212:215], v[40:43], v[136:139]
    ds_read_b128 v[40:43], v12 offset:19456
    v_mfma_f32_16x16x32_bf16 v[108:111], a[204:207], v[44:47], v[108:111]
    buffer_load_dwordx4 v[56:59], v5, s[12:15], s42 offen offset:0 sc1
    v_mfma_f32_16x16x32_bf16 v[124:127], a[208:211], v[44:47], v[124:127]
    v_mfma_f32_16x16x32_bf16 v[140:143], a[212:215], v[44:47], v[140:143]
    ds_read_b128 v[44:47], v12 offset:39936
    v_mfma_f32_16x16x32_bf16 v[112:115], a[204:207], v[48:51], v[112:115]
    v_mfma_f32_16x16x32_bf16 v[128:131], a[208:211], v[48:51], v[128:131]
    buffer_load_dwordx4 v[60:63], v5, s[12:15], s43 offen offset:0 sc1
    v_mfma_f32_16x16x32_bf16 v[144:147], a[212:215], v[48:51], v[144:147]
    ds_read_b128 v[48:51], v13 offset:19456
    v_mfma_f32_16x16x32_bf16 v[116:119], a[204:207], v[52:55], v[116:119]
    v_mfma_f32_16x16x32_bf16 v[132:135], a[208:211], v[52:55], v[132:135]
    s_waitcnt lgkmcnt(3)
    v_mfma_f32_16x16x32_bf16 v[148:151], a[212:215], v[52:55], v[148:151]
    ds_read_b128 v[52:55], v13 offset:39936
    v_mfma_f32_16x16x32_bf16 v[104:107], a[216:219], v[24:27], v[104:107]
    buffer_load_dwordx4 v[64:67], v5, s[12:15], s42 offen offset:1024 sc1
    v_mfma_f32_16x16x32_bf16 v[120:123], a[220:223], v[24:27], v[120:123]
    v_mfma_f32_16x16x32_bf16 v[136:139], a[224:227], v[24:27], v[136:139]
    v_mfma_f32_16x16x32_bf16 v[108:111], a[216:219], v[28:31], v[108:111]
    v_mfma_f32_16x16x32_bf16 v[124:127], a[220:223], v[28:31], v[124:127]
    buffer_load_dwordx4 v[68:71], v5, s[12:15], s43 offen offset:1024 sc1
    v_mfma_f32_16x16x32_bf16 v[140:143], a[224:227], v[28:31], v[140:143]
    v_mfma_f32_16x16x32_bf16 v[112:115], a[216:219], v[32:35], v[112:115]
    v_mfma_f32_16x16x32_bf16 v[128:131], a[220:223], v[32:35], v[128:131]
    v_mfma_f32_16x16x32_bf16 v[144:147], a[224:227], v[32:35], v[144:147]
    v_mfma_f32_16x16x32_bf16 v[116:119], a[216:219], v[36:39], v[116:119]
    buffer_load_dwordx4 v[72:75], v5, s[12:15], s42 offen offset:2048 sc1
    v_mfma_f32_16x16x32_bf16 v[132:135], a[220:223], v[36:39], v[132:135]
    s_waitcnt lgkmcnt(3)
    v_mfma_f32_16x16x32_bf16 v[148:151], a[224:227], v[36:39], v[148:151]
    v_mfma_f32_16x16x32_bf16 v[104:107], a[228:231], v[40:43], v[104:107]
    v_mfma_f32_16x16x32_bf16 v[120:123], a[232:235], v[40:43], v[120:123]
    v_mfma_f32_16x16x32_bf16 v[136:139], a[236:239], v[40:43], v[136:139]
    buffer_load_dwordx4 v[76:79], v5, s[12:15], s43 offen offset:2048 sc1
    s_waitcnt lgkmcnt(2)
    v_mfma_f32_16x16x32_bf16 v[108:111], a[228:231], v[44:47], v[108:111]
    v_mfma_f32_16x16x32_bf16 v[124:127], a[232:235], v[44:47], v[124:127]
    v_mfma_f32_16x16x32_bf16 v[140:143], a[236:239], v[44:47], v[140:143]
    s_waitcnt lgkmcnt(1)
    v_mfma_f32_16x16x32_bf16 v[112:115], a[228:231], v[48:51], v[112:115]
    v_mfma_f32_16x16x32_bf16 v[128:131], a[232:235], v[48:51], v[128:131]
    buffer_load_dwordx4 v[80:83], v5, s[12:15], s42 offen offset:3072 sc1
    v_mfma_f32_16x16x32_bf16 v[144:147], a[236:239], v[48:51], v[144:147]
    s_add_u32 s42, s42, 4096
    s_waitcnt lgkmcnt(0)
    v_mfma_f32_16x16x32_bf16 v[116:119], a[228:231], v[52:55], v[116:119]
    v_mfma_f32_16x16x32_bf16 v[132:135], a[232:235], v[52:55], v[132:135]
    v_mfma_f32_16x16x32_bf16 v[148:151], a[236:239], v[52:55], v[148:151]
    buffer_load_dwordx4 v[84:87], v5, s[12:15], s43 offen offset:3072 sc1
    s_add_u32 s43, s43, 4096
    v_pk_mul_f32 v[104:105], v[104:105], v[120:121]
    v_pk_mul_f32 v[106:107], v[106:107], v[122:123]
    v_pk_mul_f32 v[108:109], v[108:109], v[124:125]
    v_pk_mul_f32 v[110:111], v[110:111], v[126:127]
    v_permlane32_swap_b32 v136, v140
    v_permlane32_swap_b32 v137, v141
    v_permlane32_swap_b32 v138, v142
    v_permlane32_swap_b32 v139, v143
    v_cvt_pk_bf16_f32 v152, v104, v105
    v_cvt_pk_bf16_f32 v153, v106, v107
    v_cvt_pk_bf16_f32 v154, v108, v109
    v_cvt_pk_bf16_f32 v155, v110, v111
    v_pk_mul_f32 v[136:137], v[136:137], v[140:141]
    v_pk_mul_f32 v[138:139], v[138:139], v[142:143]
    v_permlane16_swap_b32 v152, v154
    v_permlane16_swap_b32 v153, v155
    v_cvt_pk_bf16_f32 v160, v136, v137
    v_cvt_pk_bf16_f32 v161, v138, v139
    buffer_store_dwordx4 v[152:155], v9, s[12:15], s59 offen sc1
    v_pk_mul_f32 v[112:113], v[112:113], v[128:129]
    v_pk_mul_f32 v[114:115], v[114:115], v[130:131]
    v_pk_mul_f32 v[116:117], v[116:117], v[132:133]
    v_pk_mul_f32 v[118:119], v[118:119], v[134:135]
    v_permlane32_swap_b32 v144, v148
    v_permlane32_swap_b32 v145, v149
    v_permlane32_swap_b32 v146, v150
    v_permlane32_swap_b32 v147, v151
    v_cvt_pk_bf16_f32 v156, v112, v113
    v_cvt_pk_bf16_f32 v157, v114, v115
    v_cvt_pk_bf16_f32 v158, v116, v117
    v_cvt_pk_bf16_f32 v159, v118, v119
    v_pk_mul_f32 v[144:145], v[144:145], v[148:149]
    v_pk_mul_f32 v[146:147], v[146:147], v[150:151]
    v_permlane16_swap_b32 v156, v158
    v_permlane16_swap_b32 v157, v159
    v_cvt_pk_bf16_f32 v162, v144, v145
    v_cvt_pk_bf16_f32 v163, v146, v147
    buffer_store_dwordx4 v[156:159], v9, s[12:15], s61 offen sc1
    v_permlane16_swap_b32 v160, v162
    v_permlane16_swap_b32 v161, v163
    buffer_store_dwordx4 v[160:163], v10, s[12:15], s59 offen offset:512 sc1
    s_waitcnt vmcnt(10)
    v_mfma_f32_16x16x32_bf16 v[104:107], v[188:191], v[56:59], 0
    buffer_load_dwordx4 v[88:91], v5, s[12:15], s42 offen offset:0 sc1
    v_mfma_f32_16x16x32_bf16 v[108:111], v[192:195], v[56:59], 0
    v_mfma_f32_16x16x32_bf16 v[112:115], v[196:199], v[56:59], 0
    v_mfma_f32_16x16x32_bf16 v[116:119], v[200:203], v[56:59], 0
    buffer_load_dwordx4 v[92:95], v5, s[12:15], s43 offen offset:0 sc1
    v_mfma_f32_16x16x32_bf16 v[120:123], v[204:207], v[56:59], 0
    s_waitcnt vmcnt(11)
    v_mfma_f32_16x16x32_bf16 v[124:127], v[188:191], v[60:63], 0
    v_mfma_f32_16x16x32_bf16 v[128:131], v[192:195], v[60:63], 0
    buffer_load_dwordx4 v[96:99], v5, s[12:15], s42 offen offset:1024 sc1
    v_mfma_f32_16x16x32_bf16 v[132:135], v[196:199], v[60:63], 0
    v_mfma_f32_16x16x32_bf16 v[136:139], v[200:203], v[60:63], 0
    v_mfma_f32_16x16x32_bf16 v[140:143], v[204:207], v[60:63], 0
    s_waitcnt vmcnt(11)
    v_mfma_f32_16x16x32_bf16 v[104:107], v[208:211], v[64:67], v[104:107]
    buffer_load_dwordx4 v[100:103], v5, s[12:15], s43 offen offset:1024 sc1
    v_mfma_f32_16x16x32_bf16 v[108:111], v[212:215], v[64:67], v[108:111]
    v_mfma_f32_16x16x32_bf16 v[112:115], v[216:219], v[64:67], v[112:115]
    v_mfma_f32_16x16x32_bf16 v[116:119], v[220:223], v[64:67], v[116:119]
    buffer_load_dwordx4 a[240:243], v5, s[12:15], s42 offen offset:2048 sc1
    v_mfma_f32_16x16x32_bf16 v[120:123], v[224:227], v[64:67], v[120:123]
    s_waitcnt vmcnt(12)
    v_mfma_f32_16x16x32_bf16 v[124:127], v[208:211], v[68:71], v[124:127]
    v_mfma_f32_16x16x32_bf16 v[128:131], v[212:215], v[68:71], v[128:131]
    buffer_load_dwordx4 a[244:247], v5, s[12:15], s43 offen offset:2048 sc1
    v_mfma_f32_16x16x32_bf16 v[132:135], v[216:219], v[68:71], v[132:135]
    v_mfma_f32_16x16x32_bf16 v[136:139], v[220:223], v[68:71], v[136:139]
    v_mfma_f32_16x16x32_bf16 v[140:143], v[224:227], v[68:71], v[140:143]
    s_waitcnt vmcnt(12)
    v_mfma_f32_16x16x32_bf16 v[104:107], v[228:231], v[72:75], v[104:107]
    buffer_load_dwordx4 a[248:251], v5, s[12:15], s42 offen offset:3072 sc1
    v_mfma_f32_16x16x32_bf16 v[108:111], v[232:235], v[72:75], v[108:111]
    s_add_u32 s42, s42, 4096
    v_mfma_f32_16x16x32_bf16 v[112:115], v[236:239], v[72:75], v[112:115]
    v_mfma_f32_16x16x32_bf16 v[116:119], v[240:243], v[72:75], v[116:119]
    buffer_load_dwordx4 a[252:255], v5, s[12:15], s43 offen offset:3072 sc1
    v_mfma_f32_16x16x32_bf16 v[120:123], v[244:247], v[72:75], v[120:123]
    s_waitcnt vmcnt(13)
    v_mfma_f32_16x16x32_bf16 v[124:127], v[228:231], v[76:79], v[124:127]
    s_add_u32 s43, s43, 4096
    v_mfma_f32_16x16x32_bf16 v[128:131], v[232:235], v[76:79], v[128:131]
    buffer_load_dwordx4 a[172:175], v5, s[12:15], s42 offen offset:0 sc1
    v_mfma_f32_16x16x32_bf16 v[132:135], v[236:239], v[76:79], v[132:135]
    v_mfma_f32_16x16x32_bf16 v[136:139], v[240:243], v[76:79], v[136:139]
    v_mfma_f32_16x16x32_bf16 v[140:143], v[244:247], v[76:79], v[140:143]
    s_waitcnt vmcnt(9)
    s_barrier
    s_cmp_lg_u32 s22, 0
    s_cbranch_scc1 LHB_sig
    s_mov_b64 exec, 1
    buffer_atomic_add v3, v2, s[12:15], s51 offen sc1
    s_mov_b64 exec, -1
LHB_sig:
    v_mfma_f32_16x16x32_bf16 v[104:107], v[248:251], v[80:83], v[104:107]
    buffer_load_dwordx4 a[176:179], v5, s[12:15], s43 offen offset:0 sc1
    v_mfma_f32_16x16x32_bf16 v[108:111], v[252:255], v[80:83], v[108:111]
    v_mfma_f32_16x16x32_bf16 v[112:115], a[0:3], v[80:83], v[112:115]
    v_mfma_f32_16x16x32_bf16 v[116:119], a[4:7], v[80:83], v[116:119]
    buffer_load_dwordx4 a[120:123], v14, s[12:15], 0 offen offset:3072 sc1
    v_mfma_f32_16x16x32_bf16 v[120:123], a[8:11], v[80:83], v[120:123]
    v_mfma_f32_16x16x32_bf16 v[124:127], v[248:251], v[84:87], v[124:127]
    v_add_u32 v14, 0x1000, v14
    v_mfma_f32_16x16x32_bf16 v[128:131], v[252:255], v[84:87], v[128:131]
    buffer_load_dwordx4 a[124:127], v14, s[12:15], 0 offen offset:0 sc1
    v_mfma_f32_16x16x32_bf16 v[132:135], a[0:3], v[84:87], v[132:135]
    v_mfma_f32_16x16x32_bf16 v[136:139], a[4:7], v[84:87], v[136:139]
    v_mfma_f32_16x16x32_bf16 v[140:143], a[8:11], v[84:87], v[140:143]
    s_waitcnt vmcnt(11)
    v_mfma_f32_16x16x32_bf16 v[104:107], a[12:15], v[88:91], v[104:107]
    buffer_load_dwordx4 a[128:131], v14, s[12:15], 0 offen offset:1024 sc1
    v_mfma_f32_16x16x32_bf16 v[108:111], a[16:19], v[88:91], v[108:111]
    v_mfma_f32_16x16x32_bf16 v[112:115], a[20:23], v[88:91], v[112:115]
    v_mfma_f32_16x16x32_bf16 v[116:119], a[24:27], v[88:91], v[116:119]
    buffer_load_dwordx4 a[180:183], v5, s[12:15], s42 offen offset:1024 sc1
    v_mfma_f32_16x16x32_bf16 v[120:123], a[28:31], v[88:91], v[120:123]
    s_waitcnt vmcnt(12)
    v_mfma_f32_16x16x32_bf16 v[124:127], a[12:15], v[92:95], v[124:127]
    v_mfma_f32_16x16x32_bf16 v[128:131], a[16:19], v[92:95], v[128:131]
    buffer_load_dwordx4 a[184:187], v5, s[12:15], s43 offen offset:1024 sc1
    v_mfma_f32_16x16x32_bf16 v[132:135], a[20:23], v[92:95], v[132:135]
    v_mfma_f32_16x16x32_bf16 v[136:139], a[24:27], v[92:95], v[136:139]
    v_mfma_f32_16x16x32_bf16 v[140:143], a[28:31], v[92:95], v[140:143]
    s_waitcnt vmcnt(12)
    v_mfma_f32_16x16x32_bf16 v[104:107], a[32:35], v[96:99], v[104:107]
    buffer_load_dwordx4 a[132:135], v14, s[12:15], 0 offen offset:2048 sc1
    v_mfma_f32_16x16x32_bf16 v[108:111], a[36:39], v[96:99], v[108:111]
    v_mfma_f32_16x16x32_bf16 v[112:115], a[40:43], v[96:99], v[112:115]
    v_mfma_f32_16x16x32_bf16 v[116:119], a[44:47], v[96:99], v[116:119]
    buffer_load_dwordx4 a[136:139], v14, s[12:15], 0 offen offset:3072 sc1
    v_mfma_f32_16x16x32_bf16 v[120:123], a[48:51], v[96:99], v[120:123]
    s_waitcnt vmcnt(13)
    v_mfma_f32_16x16x32_bf16 v[124:127], a[32:35], v[100:103], v[124:127]
    v_add_u32 v14, 0x1000, v14
    v_mfma_f32_16x16x32_bf16 v[128:131], a[36:39], v[100:103], v[128:131]
    buffer_load_dwordx4 a[140:143], v14, s[12:15], 0 offen offset:0 sc1
    v_mfma_f32_16x16x32_bf16 v[132:135], a[40:43], v[100:103], v[132:135]
    v_mfma_f32_16x16x32_bf16 v[136:139], a[44:47], v[100:103], v[136:139]
    v_mfma_f32_16x16x32_bf16 v[140:143], a[48:51], v[100:103], v[140:143]
    s_waitcnt vmcnt(13)
    v_mfma_f32_16x16x32_bf16 v[104:107], a[52:55], a[240:243], v[104:107]
    buffer_load_dwordx4 a[144:147], v14, s[12:15], 0 offen offset:1024 sc1
    v_mfma_f32_16x16x32_bf16 v[108:111], a[56:59], a[240:243], v[108:111]
    v_mfma_f32_16x16x32_bf16 v[112:115], a[60:63], a[240:243], v[112:115]
    v_mfma_f32_16x16x32_bf16 v[116:119], a[64:67], a[240:243], v[116:119]
    buffer_load_dwordx4 a[148:151], v14, s[12:15], 0 offen offset:2048 sc1
    v_mfma_f32_16x16x32_bf16 v[120:123], a[68:71], a[240:243], v[120:123]
    s_waitcnt vmcnt(14)
    v_mfma_f32_16x16x32_bf16 v[124:127], a[52:55], a[244:247], v[124:127]
    v_mfma_f32_16x16x32_bf16 v[128:131], a[56:59], a[244:247], v[128:131]
    buffer_load_dwordx4 a[188:191], v5, s[12:15], s42 offen offset:2048 sc1
    v_mfma_f32_16x16x32_bf16 v[132:135], a[60:63], a[244:247], v[132:135]
    v_mfma_f32_16x16x32_bf16 v[136:139], a[64:67], a[244:247], v[136:139]
    v_mfma_f32_16x16x32_bf16 v[140:143], a[68:71], a[244:247], v[140:143]
    s_waitcnt vmcnt(14)
    v_mfma_f32_16x16x32_bf16 v[104:107], a[72:75], a[248:251], v[104:107]
    buffer_load_dwordx4 a[192:195], v5, s[12:15], s43 offen offset:2048 sc1
    v_mfma_f32_16x16x32_bf16 v[108:111], a[76:79], a[248:251], v[108:111]
    v_mfma_f32_16x16x32_bf16 v[112:115], a[80:83], a[248:251], v[112:115]
    v_mfma_f32_16x16x32_bf16 v[116:119], a[84:87], a[248:251], v[116:119]
    buffer_load_dwordx4 a[152:155], v14, s[12:15], 0 offen offset:3072 sc1
    v_mfma_f32_16x16x32_bf16 v[120:123], a[88:91], a[248:251], v[120:123]
    s_waitcnt vmcnt(15)
    v_mfma_f32_16x16x32_bf16 v[124:127], a[72:75], a[252:255], v[124:127]
    v_add_u32 v14, 0x1000, v14
    v_mfma_f32_16x16x32_bf16 v[128:131], a[76:79], a[252:255], v[128:131]
    buffer_load_dwordx4 a[156:159], v14, s[12:15], 0 offen offset:0 sc1
    v_mfma_f32_16x16x32_bf16 v[132:135], a[80:83], a[252:255], v[132:135]
    v_mfma_f32_16x16x32_bf16 v[136:139], a[84:87], a[252:255], v[136:139]
    v_mfma_f32_16x16x32_bf16 v[140:143], a[88:91], a[252:255], v[140:143]
    s_waitcnt vmcnt(15)
    v_mfma_f32_16x16x32_bf16 v[104:107], a[92:95], a[172:175], v[104:107]
    buffer_load_dword v11, v2, s[12:15], s51 offen sc1
    v_mfma_f32_16x16x32_bf16 v[108:111], a[96:99], a[172:175], v[108:111]
    v_mfma_f32_16x16x32_bf16 v[112:115], a[100:103], a[172:175], v[112:115]
    v_mfma_f32_16x16x32_bf16 v[116:119], a[104:107], a[172:175], v[116:119]
    buffer_load_dwordx4 a[160:163], v14, s[12:15], 0 offen offset:1024 sc1
    v_mfma_f32_16x16x32_bf16 v[120:123], a[108:111], a[172:175], v[120:123]
    s_waitcnt vmcnt(16)
    v_mfma_f32_16x16x32_bf16 v[124:127], a[92:95], a[176:179], v[124:127]
    v_mfma_f32_16x16x32_bf16 v[128:131], a[96:99], a[176:179], v[128:131]
    buffer_load_dwordx4 a[164:167], v14, s[12:15], 0 offen offset:2048 sc1
    v_mfma_f32_16x16x32_bf16 v[132:135], a[100:103], a[176:179], v[132:135]
    v_mfma_f32_16x16x32_bf16 v[136:139], a[104:107], a[176:179], v[136:139]
    v_mfma_f32_16x16x32_bf16 v[140:143], a[108:111], a[176:179], v[140:143]
    s_waitcnt vmcnt(13)
    v_mfma_f32_16x16x32_bf16 v[104:107], a[112:115], a[180:183], v[104:107]
    buffer_load_dwordx4 a[168:171], v14, s[12:15], 0 offen offset:3072 sc1
    v_mfma_f32_16x16x32_bf16 v[108:111], a[116:119], a[180:183], v[108:111]
    v_add_u32 v14, 0x1000, v14
    v_mfma_f32_16x16x32_bf16 v[112:115], a[120:123], a[180:183], v[112:115]
    v_mfma_f32_16x16x32_bf16 v[116:119], a[124:127], a[180:183], v[116:119]
    buffer_load_dwordx4 a[196:199], v5, s[12:15], s42 offen offset:3072 sc1
    v_mfma_f32_16x16x32_bf16 v[120:123], a[128:131], a[180:183], v[120:123]
    s_waitcnt vmcnt(14)
    v_mfma_f32_16x16x32_bf16 v[124:127], a[112:115], a[184:187], v[124:127]
    s_add_u32 s42, s42, 4096
    v_mfma_f32_16x16x32_bf16 v[128:131], a[116:119], a[184:187], v[128:131]
    buffer_load_dwordx4 a[200:203], v5, s[12:15], s43 offen offset:3072 sc1
    v_mfma_f32_16x16x32_bf16 v[132:135], a[120:123], a[184:187], v[132:135]
    s_add_u32 s43, s43, 4096
    v_mfma_f32_16x16x32_bf16 v[136:139], a[124:127], a[184:187], v[136:139]
    v_mfma_f32_16x16x32_bf16 v[140:143], a[128:131], a[184:187], v[140:143]
    s_waitcnt vmcnt(9)
    v_mfma_f32_16x16x32_bf16 v[104:107], a[132:135], a[188:191], v[104:107]
    s_mov_b64 exec, s[34:35]
    buffer_load_dwordx4 v[172:175], v16, s[12:15], s46 offen sc1
    s_mov_b64 exec, -1
    v_mfma_f32_16x16x32_bf16 v[108:111], a[136:139], a[188:191], v[108:111]
    v_mfma_f32_16x16x32_bf16 v[112:115], a[140:143], a[188:191], v[112:115]
    v_mfma_f32_16x16x32_bf16 v[116:119], a[144:147], a[188:191], v[116:119]
    s_mov_b64 exec, s[34:35]
    buffer_load_dwordx4 v[176:179], v16, s[12:15], s47 offen sc1
    s_mov_b64 exec, -1
    v_mfma_f32_16x16x32_bf16 v[120:123], a[148:151], a[188:191], v[120:123]
    s_waitcnt vmcnt(10)
    v_mfma_f32_16x16x32_bf16 v[124:127], a[132:135], a[192:195], v[124:127]
    v_mfma_f32_16x16x32_bf16 v[128:131], a[136:139], a[192:195], v[128:131]
    s_mov_b64 exec, s[34:35]
    buffer_load_dwordx4 v[180:183], v16, s[12:15], s48 offen sc1
    s_mov_b64 exec, -1
    v_mfma_f32_16x16x32_bf16 v[132:135], a[140:143], a[192:195], v[132:135]
    v_mfma_f32_16x16x32_bf16 v[136:139], a[144:147], a[192:195], v[136:139]
    v_mfma_f32_16x16x32_bf16 v[140:143], a[148:151], a[192:195], v[140:143]
    s_mov_b64 exec, s[34:35]
    buffer_load_dwordx4 v[184:187], v16, s[12:15], s49 offen sc1
    s_mov_b64 exec, -1
    s_waitcnt vmcnt(9)
    v_readfirstlane_b32 s33, v11
    s_nop 0
    s_cmp_ge_u32 s33, 16
    s_cbranch_scc0 LHB_spin
LHB_ok:
    s_waitcnt vmcnt(5)
    v_mfma_f32_16x16x32_bf16 v[104:107], a[152:155], a[196:199], v[104:107]
    v_mfma_f32_16x16x32_bf16 v[108:111], a[156:159], a[196:199], v[108:111]
    buffer_load_dwordx4 a[204:207], v5, s[12:15], s44 offen offset:0 sc1
    v_mfma_f32_16x16x32_bf16 v[112:115], a[160:163], a[196:199], v[112:115]
    v_mfma_f32_16x16x32_bf16 v[116:119], a[164:167], a[196:199], v[116:119]
    v_mfma_f32_16x16x32_bf16 v[120:123], a[168:171], a[196:199], v[120:123]
    s_waitcnt vmcnt(5)
    v_mfma_f32_16x16x32_bf16 v[124:127], a[152:155], a[200:203], v[124:127]
    v_mfma_f32_16x16x32_bf16 v[128:131], a[156:159], a[200:203], v[128:131]
    buffer_load_dwordx4 a[208:211], v5, s[12:15], s44 offen offset:1024 sc1
    v_mfma_f32_16x16x32_bf16 v[132:135], a[160:163], a[200:203], v[132:135]
    v_mfma_f32_16x16x32_bf16 v[136:139], a[164:167], a[200:203], v[136:139]
    v_mfma_f32_16x16x32_bf16 v[140:143], a[168:171], a[200:203], v[140:143]
    ds_write_b128 v17, v[104:107] offset:0
    ds_write_b128 v19, v[108:111] offset:0
    buffer_load_dwordx4 a[212:215], v5, s[12:15], s44 offen offset:2048 sc1
    ds_write_b128 v17, v[112:115] offset:16
    ds_write_b128 v19, v[116:119] offset:16
    buffer_load_dwordx4 a[216:219], v5, s[12:15], s44 offen offset:3072 sc1
    s_add_u32 s44, s44, 4096
    ds_write_b128 v17, v[120:123] offset:32
    ds_write_b128 v17, v[124:127] offset:21504
    buffer_load_dwordx4 a[220:223], v5, s[12:15], s44 offen offset:0 sc1
    ds_write_b128 v19, v[128:131] offset:21504
    ds_write_b128 v17, v[132:135] offset:21520
    buffer_load_dwordx4 a[224:227], v5, s[12:15], s44 offen offset:1024 sc1
    ds_write_b128 v19, v[136:139] offset:21520
    ds_write_b128 v17, v[140:143] offset:21536
    buffer_load_dwordx4 a[228:231], v5, s[12:15], s44 offen offset:2048 sc1
    s_waitcnt lgkmcnt(0)
    s_barrier
    ds_read_b128 v[104:107], v18 offset:0
    ds_read_b128 v[108:111], v18 offset:160
    ds_read_b128 v[112:115], v18 offset:5376
    ds_read_b128 v[116:119], v18 offset:5536
    ds_read_b128 v[120:123], v18 offset:10752
    ds_read_b128 v[124:127], v18 offset:10912
    ds_read_b128 v[128:131], v18 offset:16128
    ds_read_b128 v[132:135], v18 offset:16288
    buffer_load_dwordx4 a[232:235], v5, s[12:15], s44 offen offset:3072 sc1
    s_add_u32 s44, s44, 4096
    ds_read_b128 v[24:27], v18 offset:21504
    ds_read_b128 v[28:31], v18 offset:21664
    ds_read_b128 v[32:35], v18 offset:26880
    ds_read_b128 v[36:39], v18 offset:27040
    ds_read_b128 v[40:43], v18 offset:32256
    ds_read_b128 v[44:47], v18 offset:32416
    ds_read_b128 v[48:51], v18 offset:37632
    ds_read_b128 v[52:55], v18 offset:37792
    buffer_load_dwordx4 a[236:239], v5, s[12:15], s44 offen offset:0 sc1
    s_waitcnt vmcnt(12)
    v_lshlrev_b32 v152, 16, v172
    v_and_b32 v153, 0xffff0000, v172
    v_lshlrev_b32 v154, 16, v173
    v_and_b32 v155, 0xffff0000, v173
    v_lshlrev_b32 v156, 16, v174
    v_and_b32 v157, 0xffff0000, v174
    v_lshlrev_b32 v158, 16, v175
    v_and_b32 v159, 0xffff0000, v175
    s_waitcnt lgkmcnt(13)
    v_pk_add_f32 v[104:105], v[104:105], v[112:113]
    v_pk_add_f32 v[106:107], v[106:107], v[114:115]
    s_waitcnt lgkmcnt(12)
    v_pk_add_f32 v[108:109], v[108:109], v[116:117]
    v_pk_add_f32 v[110:111], v[110:111], v[118:119]
    s_waitcnt lgkmcnt(9)
    v_pk_add_f32 v[120:121], v[120:121], v[128:129]
    v_pk_add_f32 v[122:123], v[122:123], v[130:131]
    buffer_load_dwordx4 v[56:59], v5, s[12:15], s44 offen offset:1024 sc1
    s_waitcnt lgkmcnt(8)
    v_pk_add_f32 v[124:125], v[124:125], v[132:133]
    v_pk_add_f32 v[126:127], v[126:127], v[134:135]
    v_pk_add_f32 v[104:105], v[104:105], v[120:121]
    v_pk_add_f32 v[106:107], v[106:107], v[122:123]
    v_pk_add_f32 v[108:109], v[108:109], v[124:125]
    v_pk_add_f32 v[110:111], v[110:111], v[126:127]
    v_pk_fma_f32 v[152:153], v[104:105], v[164:165], v[152:153]
    v_pk_fma_f32 v[154:155], v[106:107], v[166:167], v[154:155]
    v_pk_fma_f32 v[156:157], v[108:109], v[168:169], v[156:157]
    v_pk_fma_f32 v[158:159], v[110:111], v[170:171], v[158:159]
    v_cvt_pk_bf16_f32 v172, v152, v153
    v_cvt_pk_bf16_f32 v173, v154, v155
    v_cvt_pk_bf16_f32 v174, v156, v157
    v_cvt_pk_bf16_f32 v175, v158, v159
    buffer_load_dwordx4 v[60:63], v5, s[12:15], s44 offen offset:2048 sc1
    s_waitcnt vmcnt(10)
    v_mfma_f32_16x16x32_bf16 v[104:107], v[188:191], a[204:207], 0
    buffer_load_dwordx4 v[64:67], v5, s[12:15], s44 offen offset:3072 sc1
    v_mfma_f32_16x16x32_bf16 v[108:111], v[192:195], a[204:207], 0
    s_add_u32 s44, s44, 4096
    v_mfma_f32_16x16x32_bf16 v[112:115], v[196:199], a[204:207], 0
    v_lshlrev_b32 v144, 16, v176
    v_mfma_f32_16x16x32_bf16 v[116:119], v[200:203], a[204:207], 0
    v_and_b32 v145, 0xffff0000, v176
    v_mfma_f32_16x16x32_bf16 v[120:123], v[204:207], a[204:207], 0
    s_waitcnt vmcnt(10)
    v_mfma_f32_16x16x32_bf16 v[104:107], v[208:211], a[208:211], v[104:107]
    buffer_load_dwordx4 v[68:71], v5, s[12:15], s45 offen offset:0 sc1
    v_mfma_f32_16x16x32_bf16 v[108:111], v[212:215], a[208:211], v[108:111]
    v_lshlrev_b32 v146, 16, v177
    v_mfma_f32_16x16x32_bf16 v[112:115], v[216:219], a[208:211], v[112:115]
    v_and_b32 v147, 0xffff0000, v177
    v_mfma_f32_16x16x32_bf16 v[116:119], v[220:223], a[208:211], v[116:119]
    v_lshlrev_b32 v148, 16, v178
    v_mfma_f32_16x16x32_bf16 v[120:123], v[224:227], a[208:211], v[120:123]
    s_waitcnt vmcnt(10)
    v_mfma_f32_16x16x32_bf16 v[104:107], v[228:231], a[212:215], v[104:107]
    buffer_load_dwordx4 v[72:75], v5, s[12:15], s45 offen offset:1024 sc1
    v_mfma_f32_16x16x32_bf16 v[108:111], v[232:235], a[212:215], v[108:111]
    v_and_b32 v149, 0xffff0000, v178
    v_mfma_f32_16x16x32_bf16 v[112:115], v[236:239], a[212:215], v[112:115]
    v_lshlrev_b32 v150, 16, v179
    v_mfma_f32_16x16x32_bf16 v[116:119], v[240:243], a[212:215], v[116:119]
    v_and_b32 v151, 0xffff0000, v179
    v_mfma_f32_16x16x32_bf16 v[120:123], v[244:247], a[212:215], v[120:123]
    s_waitcnt vmcnt(10)
    v_mfma_f32_16x16x32_bf16 v[104:107], v[248:251], a[216:219], v[104:107]
    buffer_load_dwordx4 v[76:79], v5, s[12:15], s45 offen offset:2048 sc1
    v_mfma_f32_16x16x32_bf16 v[108:111], v[252:255], a[216:219], v[108:111]
    s_waitcnt lgkmcnt(5)
    v_add_f32 v24, v24, v32
    v_add_f32 v25, v25, v33
    v_mfma_f32_16x16x32_bf16 v[112:115], a[0:3], a[216:219], v[112:115]
    v_add_f32 v26, v26, v34
    v_add_f32 v27, v27, v35
    v_mfma_f32_16x16x32_bf16 v[116:119], a[4:7], a[216:219], v[116:119]
    s_waitcnt lgkmcnt(4)
    v_add_f32 v28, v28, v36
    v_add_f32 v29, v29, v37
    v_mfma_f32_16x16x32_bf16 v[120:123], a[8:11], a[216:219], v[120:123]
    s_waitcnt vmcnt(10)
    v_mfma_f32_16x16x32_bf16 v[104:107], a[12:15], a[220:223], v[104:107]
    buffer_load_dwordx4 v[80:83], v5, s[12:15], s45 offen offset:3072 sc1
    v_mfma_f32_16x16x32_bf16 v[108:111], a[16:19], a[220:223], v[108:111]
    s_add_u32 s45, s45, 4096
    v_mfma_f32_16x16x32_bf16 v[112:115], a[20:23], a[220:223], v[112:115]
    v_add_f32 v30, v30, v38
    v_add_f32 v31, v31, v39
    v_mfma_f32_16x16x32_bf16 v[116:119], a[24:27], a[220:223], v[116:119]
    s_waitcnt lgkmcnt(1)
    v_add_f32 v40, v40, v48
    v_add_f32 v41, v41, v49
    v_mfma_f32_16x16x32_bf16 v[120:123], a[28:31], a[220:223], v[120:123]
    s_waitcnt vmcnt(10)
    v_mfma_f32_16x16x32_bf16 v[104:107], a[32:35], a[224:227], v[104:107]
    buffer_load_dwordx4 v[84:87], v5, s[12:15], s45 offen offset:0 sc1
    v_mfma_f32_16x16x32_bf16 v[108:111], a[36:39], a[224:227], v[108:111]
    v_add_f32 v42, v42, v50
    v_add_f32 v43, v43, v51
    v_mfma_f32_16x16x32_bf16 v[112:115], a[40:43], a[224:227], v[112:115]
    s_waitcnt lgkmcnt(0)
    v_add_f32 v44, v44, v52
    v_add_f32 v45, v45, v53
    v_mfma_f32_16x16x32_bf16 v[116:119], a[44:47], a[224:227], v[116:119]
    v_add_f32 v46, v46, v54
    v_add_f32 v47, v47, v55
    v_mfma_f32_16x16x32_bf16 v[120:123], a[48:51], a[224:227], v[120:123]
    s_waitcnt vmcnt(10)
    v_mfma_f32_16x16x32_bf16 v[104:107], a[52:55], a[228:231], v[104:107]
    buffer_load_dwordx4 v[88:91], v5, s[12:15], s45 offen offset:1024 sc1
    v_mfma_f32_16x16x32_bf16 v[108:111], a[56:59], a[228:231], v[108:111]
    v_add_f32 v24, v24, v40
    v_add_f32 v25, v25, v41
    v_mfma_f32_16x16x32_bf16 v[112:115], a[60:63], a[228:231], v[112:115]
    v_add_f32 v26, v26, v42
    v_add_f32 v27, v27, v43
    v_mfma_f32_16x16x32_bf16 v[116:119], a[64:67], a[228:231], v[116:119]
    v_add_f32 v28, v28, v44
    v_add_f32 v29, v29, v45
    v_mfma_f32_16x16x32_bf16 v[120:123], a[68:71], a[228:231], v[120:123]
    s_waitcnt vmcnt(10)
    v_mfma_f32_16x16x32_bf16 v[104:107], a[72:75], a[232:235], v[104:107]
    buffer_load_dwordx4 v[92:95], v5, s[12:15], s45 offen offset:2048 sc1
    v_mfma_f32_16x16x32_bf16 v[108:111], a[76:79], a[232:235], v[108:111]
    v_add_f32 v30, v30, v46
    v_add_f32 v31, v31, v47
    v_mfma_f32_16x16x32_bf16 v[112:115], a[80:83], a[232:235], v[112:115]
    v_fmac_f32 v144, v24, v164
    v_fmac_f32 v145, v25, v165
    v_mfma_f32_16x16x32_bf16 v[116:119], a[84:87], a[232:235], v[116:119]
    v_fmac_f32 v146, v26, v166
    v_fmac_f32 v147, v27, v167
    v_mfma_f32_16x16x32_bf16 v[120:123], a[88:91], a[232:235], v[120:123]
    s_waitcnt vmcnt(10)
    v_mfma_f32_16x16x32_bf16 v[104:107], a[92:95], a[236:239], v[104:107]
    buffer_load_dwordx4 v[96:99], v5, s[12:15], s45 offen offset:3072 sc1
    v_mfma_f32_16x16x32_bf16 v[108:111], a[96:99], a[236:239], v[108:111]
    s_add_u32 s45, s45, 4096
    v_mfma_f32_16x16x32_bf16 v[112:115], a[100:103], a[236:239], v[112:115]
    v_fmac_f32 v148, v28, v168
    v_fmac_f32 v149, v29, v169
    v_mfma_f32_16x16x32_bf16 v[116:119], a[104:107], a[236:239], v[116:119]
    v_fmac_f32 v150, v30, v170
    v_fmac_f32 v151, v31, v171
    v_mfma_f32_16x16x32_bf16 v[120:123], a[108:111], a[236:239], v[120:123]
    s_waitcnt vmcnt(10)
    v_mfma_f32_16x16x32_bf16 v[104:107], a[112:115], v[56:59], v[104:107]
    buffer_load_dwordx4 v[100:103], v5, s[12:15], s45 offen offset:0 sc1
    v_mfma_f32_16x16x32_bf16 v[108:111], a[116:119], v[56:59], v[108:111]
    v_cvt_pk_bf16_f32 v176, v144, v145
    v_mfma_f32_16x16x32_bf16 v[112:115], a[120:123], v[56:59], v[112:115]
    v_cvt_pk_bf16_f32 v177, v146, v147
    v_mfma_f32_16x16x32_bf16 v[116:119], a[124:127], v[56:59], v[116:119]
    v_cvt_pk_bf16_f32 v178, v148, v149
    v_mfma_f32_16x16x32_bf16 v[120:123], a[128:131], v[56:59], v[120:123]
    s_waitcnt vmcnt(10)
    v_mfma_f32_16x16x32_bf16 v[104:107], a[132:135], v[60:63], v[104:107]
    buffer_load_dwordx4 a[240:243], v5, s[12:15], s45 offen offset:1024 sc1
    v_mfma_f32_16x16x32_bf16 v[108:111], a[136:139], v[60:63], v[108:111]
    v_cvt_pk_bf16_f32 v179, v150, v151
    v_mfma_f32_16x16x32_bf16 v[112:115], a[140:143], v[60:63], v[112:115]
    v_mfma_f32_16x16x32_bf16 v[116:119], a[144:147], v[60:63], v[116:119]
    v_mfma_f32_16x16x32_bf16 v[120:123], a[148:151], v[60:63], v[120:123]
    s_waitcnt vmcnt(10)
    v_mfma_f32_16x16x32_bf16 v[104:107], a[152:155], v[64:67], v[104:107]
    buffer_load_dwordx4 a[244:247], v5, s[12:15], s45 offen offset:2048 sc1
    v_mfma_f32_16x16x32_bf16 v[108:111], a[156:159], v[64:67], v[108:111]
    v_mfma_f32_16x16x32_bf16 v[112:115], a[160:163], v[64:67], v[112:115]
    v_mfma_f32_16x16x32_bf16 v[116:119], a[164:167], v[64:67], v[116:119]
    v_mfma_f32_16x16x32_bf16 v[120:123], a[168:171], v[64:67], v[120:123]
    s_waitcnt vmcnt(10)
    v_mfma_f32_16x16x32_bf16 v[124:127], v[188:191], v[68:71], 0
    buffer_load_dwordx4 a[248:251], v5, s[12:15], s45 offen offset:3072 sc1
    v_mfma_f32_16x16x32_bf16 v[128:131], v[192:195], v[68:71], 0
    s_add_u32 s45, s45, 4096
    v_mfma_f32_16x16x32_bf16 v[132:135], v[196:199], v[68:71], 0
    v_mfma_f32_16x16x32_bf16 v[136:139], v[200:203], v[68:71], 0
    v_mfma_f32_16x16x32_bf16 v[140:143], v[204:207], v[68:71], 0
    s_waitcnt vmcnt(10)
    v_mfma_f32_16x16x32_bf16 v[124:127], v[208:211], v[72:75], v[124:127]
    s_mov_b64 exec, s[34:35]
    buffer_store_dwordx4 v[172:175], v15, s[36:39], s25 offen
    s_mov_b64 exec, -1
    v_mfma_f32_16x16x32_bf16 v[128:131], v[212:215], v[72:75], v[128:131]
    ds_write_b128 v17, v[104:107] offset:43008
    v_mfma_f32_16x16x32_bf16 v[132:135], v[216:219], v[72:75], v[132:135]
    ds_write_b128 v19, v[108:111] offset:43008
    v_mfma_f32_16x16x32_bf16 v[136:139], v[220:223], v[72:75], v[136:139]
    ds_write_b128 v17, v[112:115] offset:43024
    v_mfma_f32_16x16x32_bf16 v[140:143], v[224:227], v[72:75], v[140:143]
    s_waitcnt vmcnt(10)
    v_mfma_f32_16x16x32_bf16 v[124:127], v[228:231], v[76:79], v[124:127]
    s_mov_b64 exec, s[34:35]
    buffer_store_dwordx4 v[176:179], v15, s[36:39], s26 offen
    s_mov_b64 exec, -1
    v_mfma_f32_16x16x32_bf16 v[128:131], v[232:235], v[76:79], v[128:131]
    ds_write_b128 v19, v[116:119] offset:43024
    v_mfma_f32_16x16x32_bf16 v[132:135], v[236:239], v[76:79], v[132:135]
    ds_write_b128 v17, v[120:123] offset:43040
    v_mfma_f32_16x16x32_bf16 v[136:139], v[240:243], v[76:79], v[136:139]
    v_mfma_f32_16x16x32_bf16 v[140:143], v[244:247], v[76:79], v[140:143]
    s_waitcnt vmcnt(10)
    v_mfma_f32_16x16x32_bf16 v[124:127], v[248:251], v[80:83], v[124:127]
    v_mfma_f32_16x16x32_bf16 v[128:131], v[252:255], v[80:83], v[128:131]
    v_mfma_f32_16x16x32_bf16 v[132:135], a[0:3], v[80:83], v[132:135]
    v_mfma_f32_16x16x32_bf16 v[136:139], a[4:7], v[80:83], v[136:139]
    v_mfma_f32_16x16x32_bf16 v[140:143], a[8:11], v[80:83], v[140:143]
    s_waitcnt lgkmcnt(0)
    s_barrier
    s_waitcnt vmcnt(9)
    v_mfma_f32_16x16x32_bf16 v[124:127], a[12:15], v[84:87], v[124:127]
    ds_read_b128 v[188:191], v18 offset:43008
    v_mfma_f32_16x16x32_bf16 v[128:131], a[16:19], v[84:87], v[128:131]
    ds_read_b128 v[192:195], v18 offset:43168
    v_mfma_f32_16x16x32_bf16 v[132:135], a[20:23], v[84:87], v[132:135]
    ds_read_b128 v[196:199], v18 offset:48384
    v_mfma_f32_16x16x32_bf16 v[136:139], a[24:27], v[84:87], v[136:139]
    ds_read_b128 v[200:203], v18 offset:48544
    v_mfma_f32_16x16x32_bf16 v[140:143], a[28:31], v[84:87], v[140:143]
    s_waitcnt vmcnt(8)
    v_mfma_f32_16x16x32_bf16 v[124:127], a[32:35], v[88:91], v[124:127]
    ds_read_b128 v[204:207], v18 offset:53760
    v_mfma_f32_16x16x32_bf16 v[128:131], a[36:39], v[88:91], v[128:131]
    ds_read_b128 v[208:211], v18 offset:53920
    v_mfma_f32_16x16x32_bf16 v[132:135], a[40:43], v[88:91], v[132:135]
    ds_read_b128 v[212:215], v18 offset:59136
    v_mfma_f32_16x16x32_bf16 v[136:139], a[44:47], v[88:91], v[136:139]
    ds_read_b128 v[216:219], v18 offset:59296
    v_mfma_f32_16x16x32_bf16 v[140:143], a[48:51], v[88:91], v[140:143]
    s_waitcnt vmcnt(7)
    v_mfma_f32_16x16x32_bf16 v[124:127], a[52:55], v[92:95], v[124:127]
    v_lshlrev_b32 v152, 16, v180
    v_mfma_f32_16x16x32_bf16 v[128:131], a[56:59], v[92:95], v[128:131]
    v_and_b32 v153, 0xffff0000, v180
    v_mfma_f32_16x16x32_bf16 v[132:135], a[60:63], v[92:95], v[132:135]
    v_lshlrev_b32 v154, 16, v181
    v_mfma_f32_16x16x32_bf16 v[136:139], a[64:67], v[92:95], v[136:139]
    v_and_b32 v155, 0xffff0000, v181
    v_mfma_f32_16x16x32_bf16 v[140:143], a[68:71], v[92:95], v[140:143]
    s_waitcnt vmcnt(6)
    v_mfma_f32_16x16x32_bf16 v[124:127], a[72:75], v[96:99], v[124:127]
    v_lshlrev_b32 v156, 16, v182
    v_mfma_f32_16x16x32_bf16 v[128:131], a[76:79], v[96:99], v[128:131]
    v_and_b32 v157, 0xffff0000, v182
    v_mfma_f32_16x16x32_bf16 v[132:135], a[80:83], v[96:99], v[132:135]
    v_lshlrev_b32 v158, 16, v183
    v_mfma_f32_16x16x32_bf16 v[136:139], a[84:87], v[96:99], v[136:139]
    v_and_b32 v159, 0xffff0000, v183
    v_mfma_f32_16x16x32_bf16 v[140:143], a[88:91], v[96:99], v[140:143]
    s_waitcnt vmcnt(5)
    v_mfma_f32_16x16x32_bf16 v[124:127], a[92:95], v[100:103], v[124:127]
    s_waitcnt lgkmcnt(5)
    v_add_f32 v188, v188, v196
    v_add_f32 v189, v189, v197
    v_mfma_f32_16x16x32_bf16 v[128:131], a[96:99], v[100:103], v[128:131]
    v_add_f32 v190, v190, v198
    v_add_f32 v191, v191, v199
    v_mfma_f32_16x16x32_bf16 v[132:135], a[100:103], v[100:103], v[132:135]
    s_waitcnt lgkmcnt(4)
    v_add_f32 v192, v192, v200
    v_add_f32 v193, v193, v201
    v_mfma_f32_16x16x32_bf16 v[136:139], a[104:107], v[100:103], v[136:139]
    v_add_f32 v194, v194, v202
    v_add_f32 v195, v195, v203
    v_mfma_f32_16x16x32_bf16 v[140:143], a[108:111], v[100:103], v[140:143]
    s_waitcnt vmcnt(4)
    v_mfma_f32_16x16x32_bf16 v[124:127], a[112:115], a[240:243], v[124:127]
    s_waitcnt lgkmcnt(1)
    v_add_f32 v204, v204, v212
    v_add_f32 v205, v205, v213
    v_mfma_f32_16x16x32_bf16 v[128:131], a[116:119], a[240:243], v[128:131]
    v_add_f32 v206, v206, v214
    v_add_f32 v207, v207, v215
    v_mfma_f32_16x16x32_bf16 v[132:135], a[120:123], a[240:243], v[132:135]
    s_waitcnt lgkmcnt(0)
    v_add_f32 v208, v208, v216
    v_add_f32 v209, v209, v217
    v_mfma_f32_16x16x32_bf16 v[136:139], a[124:127], a[240:243], v[136:139]
    v_add_f32 v210, v210, v218
    v_add_f32 v211, v211, v219
    v_mfma_f32_16x16x32_bf16 v[140:143], a[128:131], a[240:243], v[140:143]
    s_waitcnt vmcnt(3)
    v_mfma_f32_16x16x32_bf16 v[124:127], a[132:135], a[244:247], v[124:127]
    v_add_f32 v188, v188, v204
    v_add_f32 v189, v189, v205
    v_mfma_f32_16x16x32_bf16 v[128:131], a[136:139], a[244:247], v[128:131]
    v_add_f32 v190, v190, v206
    v_add_f32 v191, v191, v207
    v_mfma_f32_16x16x32_bf16 v[132:135], a[140:143], a[244:247], v[132:135]
    v_add_f32 v192, v192, v208
    v_add_f32 v193, v193, v209
    v_mfma_f32_16x16x32_bf16 v[136:139], a[144:147], a[244:247], v[136:139]
    v_add_f32 v194, v194, v210
    v_add_f32 v195, v195, v211
    v_mfma_f32_16x16x32_bf16 v[140:143], a[148:151], a[244:247], v[140:143]
    v_fmac_f32 v152, v188, v164
    v_fmac_f32 v153, v189, v165
    s_waitcnt vmcnt(2)
    v_mfma_f32_16x16x32_bf16 v[124:127], a[152:155], a[248:251], v[124:127]
    v_fmac_f32 v154, v190, v166
    v_fmac_f32 v155, v191, v167
    v_mfma_f32_16x16x32_bf16 v[128:131], a[156:159], a[248:251], v[128:131]
    v_fmac_f32 v156, v192, v168
    v_fmac_f32 v157, v193, v169
    v_mfma_f32_16x16x32_bf16 v[132:135], a[160:163], a[248:251], v[132:135]
    v_fmac_f32 v158, v194, v170
    v_fmac_f32 v159, v195, v171
    v_mfma_f32_16x16x32_bf16 v[136:139], a[164:167], a[248:251], v[136:139]
    v_cvt_pk_bf16_f32 v180, v152, v153
    v_mfma_f32_16x16x32_bf16 v[140:143], a[168:171], a[248:251], v[140:143]
    v_cvt_pk_bf16_f32 v181, v154, v155
    v_cvt_pk_bf16_f32 v182, v156, v157
    v_cvt_pk_bf16_f32 v183, v158, v159
    s_mov_b64 exec, s[34:35]
    buffer_store_dwordx4 v[180:183], v15, s[36:39], s27 offen
    s_mov_b64 exec, -1
    ds_write_b128 v17, v[124:127] offset:0
    ds_write_b128 v19, v[128:131] offset:0
    ds_write_b128 v17, v[132:135] offset:16
    ds_write_b128 v19, v[136:139] offset:16
    ds_write_b128 v17, v[140:143] offset:32
    v_lshlrev_b32 v24, 16, v184
    v_and_b32 v25, 0xffff0000, v184
    v_lshlrev_b32 v26, 16, v185
    v_and_b32 v27, 0xffff0000, v185
    v_lshlrev_b32 v28, 16, v186
    v_and_b32 v29, 0xffff0000, v186
    v_lshlrev_b32 v30, 16, v187
    v_and_b32 v31, 0xffff0000, v187
    s_waitcnt lgkmcnt(0)
    s_barrier
    ds_read_b128 v[220:223], v18 offset:0
    ds_read_b128 v[224:227], v18 offset:160
    ds_read_b128 v[228:231], v18 offset:5376
    ds_read_b128 v[232:235], v18 offset:5536
    ds_read_b128 v[236:239], v18 offset:10752
    ds_read_b128 v[240:243], v18 offset:10912
    ds_read_b128 v[244:247], v18 offset:16128
    ds_read_b128 v[248:251], v18 offset:16288
    s_waitcnt lgkmcnt(5)
    v_pk_add_f32 v[220:221], v[220:221], v[228:229]
    v_pk_add_f32 v[222:223], v[222:223], v[230:231]
    s_waitcnt lgkmcnt(4)
    v_pk_add_f32 v[224:225], v[224:225], v[232:233]
    v_pk_add_f32 v[226:227], v[226:227], v[234:235]
    s_waitcnt lgkmcnt(1)
    v_pk_add_f32 v[236:237], v[236:237], v[244:245]
    v_pk_add_f32 v[238:239], v[238:239], v[246:247]
    s_waitcnt lgkmcnt(0)
    v_pk_add_f32 v[240:241], v[240:241], v[248:249]
    v_pk_add_f32 v[242:243], v[242:243], v[250:251]
    v_pk_add_f32 v[220:221], v[220:221], v[236:237]
    v_pk_add_f32 v[222:223], v[222:223], v[238:239]
    v_pk_add_f32 v[224:225], v[224:225], v[240:241]
    v_pk_add_f32 v[226:227], v[226:227], v[242:243]
    v_pk_fma_f32 v[24:25], v[220:221], v[164:165], v[24:25]
    v_pk_fma_f32 v[26:27], v[222:223], v[166:167], v[26:27]
    v_pk_fma_f32 v[28:29], v[224:225], v[168:169], v[28:29]
    v_pk_fma_f32 v[30:31], v[226:227], v[170:171], v[30:31]
    v_cvt_pk_bf16_f32 v184, v24, v25
    v_cvt_pk_bf16_f32 v185, v26, v27
    v_cvt_pk_bf16_f32 v186, v28, v29
    v_cvt_pk_bf16_f32 v187, v30, v31
    s_mov_b64 exec, s[34:35]
    buffer_store_dwordx4 v[184:187], v15, s[36:39], s28 offen
    s_mov_b64 exec, -1
LD_exit:
    s_endpgm
LXG_slow:
    s_mov_b32 s24, 0x40000
LXG_loop:
    s_sleep 2
    s_mov_b32 m0, s48
    s_nop 0
    buffer_load_dwordx4 v232, s[12:15], s36 offen offset:0 sc1 lds
    buffer_load_dwordx4 v232, s[12:15], s37 offen offset:1024 sc1 lds
    buffer_load_dwordx4 v232, s[12:15], s38 offen offset:2048 sc1 lds
    buffer_load_dwordx4 v232, s[12:15], s39 offen offset:3072 sc1 lds
    s_waitcnt vmcnt(0)
    s_sub_u32 s24, s24, 1
    s_cbranch_scc1 LXG_ok
    ds_read2st64_b32 v[234:235], v233 offset0:0 offset1:4
    ds_read2st64_b32 v[236:237], v233 offset0:8 offset1:12
    s_waitcnt lgkmcnt(0)
    v_bitop3_b32 v234, v234, v235, v236 bitop3:0x80
    v_bitop3_b32 v234, v234, v237, 1 bitop3:0x80
    v_cmp_eq_u32 s[98:99], 0, v234
    s_nop 0
    s_cmp_lg_u64 s[98:99], 0
    s_nop 1
    s_cbranch_scc1 LXG_loop
    s_branch LXG_ok
LY_slow:
    s_mov_b32 s24, 0x40000
LY_loop:
    s_add_u32 s50, s50, 1
    s_sleep 2
    s_mov_b32 m0, s88
    s_nop 0
    buffer_load_dwordx4 v5, s[12:15], s31 offen sc1 lds
    buffer_load_dwordx4 v5, s[12:15], s31 offen offset:1024 sc1 lds
    buffer_load_dwordx4 v[24:27], v12, s[16:19], s25 offen sc1
    buffer_load_dwordx4 v[28:31], v12, s[16:19], s26 offen sc1
    s_mov_b64 exec, s[34:35]
    buffer_load_dwordx4 v[32:35], v12, s[16:19], s27 offen sc1
    s_mov_b64 exec, -1
    s_waitcnt vmcnt(0)
    s_sub_u32 s24, s24, 1
    s_cbranch_scc1 LY_ok
    v_and_b32 v90, v24, v28
    ds_read2st64_b32 v[94:95], v93 offset0:0 offset1:4
    v_and_b32 v90, v90, v32
    v_and_b32 v90, 1, v90
    v_add_u32 v90, -1, v90
    s_waitcnt lgkmcnt(0)
    v_max3_u32 v90, v90, v94, v95
    v_cmp_eq_u32 s[62:63], -1, v90
    s_nop 0
    s_cmp_lg_u64 s[62:63], 0
    s_nop 1
    s_cbranch_scc1 LY_loop
    s_branch LY_ok
LF0_slow:
    s_mov_b32 s33, 0x40000
LF0_loop:
    s_sleep 4
    buffer_load_dword v11, v2, s[12:15], s89 offen offset:1024 sc1
    s_waitcnt vmcnt(0)
    s_sub_u32 s33, s33, 1
    s_cbranch_scc1 LF0_ok
    v_readfirstlane_b32 s24, v11
    s_nop 0
    s_cmp_lg_u32 s24, 1
    s_nop 1
    s_cbranch_scc1 LF0_loop
    s_branch LF0_ok
LWD:
    v_add_u32 v12, 0, v4
    v_mul_u32_u24 v13, 205, v12
    v_lshrrev_b32 v13, 13, v13
    v_mul_u32_u24 v13, 640, v13
    v_add_u32 v16, v13, v5
    v_add_u32 v12, 64, v4
    v_mul_u32_u24 v13, 205, v12
    v_lshrrev_b32 v13, 13, v13
    v_mul_u32_u24 v13, 640, v13
    v_add_u32 v17, v13, v5
    v_add_u32 v12, 128, v4
    v_mul_u32_u24 v13, 205, v12
    v_lshrrev_b32 v13, 13, v13
    v_mul_u32_u24 v13, 640, v13
    v_add_u32 v18, v13, v5
    v_add_u32 v12, 192, v4
    v_mul_u32_u24 v13, 205, v12
    v_lshrrev_b32 v13, 13, v13
    v_mul_u32_u24 v13, 640, v13
    v_add_u32 v19, v13, v5
    v_add_u32 v12, 256, v4
    v_mul_u32_u24 v13, 205, v12
    v_lshrrev_b32 v13, 13, v13
    v_mul_u32_u24 v13, 640, v13
    v_add_u32 v20, v13, v5
    v_bfe_u32 v13, v4, 2, 2
    v_lshl_add_u32 v12, v8, 3, v13
    v_mul_u32_u24 v14, 640, v12
    v_and_b32 v12, 3, v4
    v_mul_u32_u24 v12, 40, v12
    s_mul_i32 s24, s22, 160
    s_add_u32 s24, s24, 81920
    v_add3_u32 v14, v14, v12, s24
    s_mul_i32 s90, s22, 5120
    s_add_u32 s90, s90, 81920
    s_sub_u32 s48, s2, 161
    s_waitcnt vmcnt(4)
    s_barrier
    v_mov_b32 v250, s100
    v_mov_b32 v251, 0
    s_lshl_b32 s98, s2, 2
    s_add_u32 s98, s98, 50176
    s_cmp_eq_u32 s22, 3
    s_cselect_b64 exec, 1, 0
    buffer_store_dword v250, v251, s[12:15], s98 offen sc1
    s_mov_b64 exec, -1
    v_add_u32 v12, 0, v4
    v_mul_u32_u24 v13, 171, v12
    v_lshrrev_b32 v13, 12, v13
    v_mul_u32_u24 v13, 2688, v13
    v_add_u32 v44, v13, v5
    v_add_u32 v12, 64, v4
    v_mul_u32_u24 v13, 171, v12
    v_lshrrev_b32 v13, 12, v13
    v_mul_u32_u24 v13, 2688, v13
    v_add_u32 v45, v13, v5
    v_add_u32 v12, 128, v4
    v_mul_u32_u24 v13, 171, v12
    v_lshrrev_b32 v13, 12, v13
    v_mul_u32_u24 v13, 2688, v13
    v_add_u32 v46, v13, v5
    s_mov_b32 s8, s92
    s_mov_b32 s9, s93
    s_mov_b32 s10, 1966080
    s_mov_b32 s11, 0x00020000
    s_mov_b32 s16, s94
    s_mov_b32 s17, s95
    s_mov_b32 s18, 1966080
    s_mov_b32 s19, 0x00020000
    s_and_b32 s49, s48, 7
    s_lshr_b32 s50, s48, 3
    s_add_u32 s50, s50, 16
    s_lshl_b32 s51, s50, 2
    s_add_u32 s51, s51, s22
    s_mul_i32 s51, s51, 24576
    s_mul_i32 s24, s49, 384
    s_add_u32 s51, s51, s24
    s_cmp_lt_u32 s48, 32
    s_cselect_b64 exec, -1, 0
    s_mul_i32 s24, s22, 3072
    s_add_u32 m0, s24, 102656
    s_nop 0
    buffer_load_dwordx4 v44, s[8:11], s51 offen offset:0 nt lds
    buffer_load_dwordx4 v45, s[8:11], s51 offen offset:1024 nt lds
    buffer_load_dwordx4 v46, s[8:11], s51 offen offset:2048 nt lds
    s_add_u32 m0, s24, 114944
    s_nop 0
    buffer_load_dwordx4 v44, s[16:19], s51 offen offset:0 nt lds
    buffer_load_dwordx4 v45, s[16:19], s51 offen offset:1024 nt lds
    buffer_load_dwordx4 v46, s[16:19], s51 offen offset:2048 nt lds
    s_mov_b64 exec, -1
    s_lshl_b32 s54, s49, 3
    s_add_u32 s54, s54, s22
    s_mul_i32 s54, s54, 10
    s_add_u32 s54, s54, s50
    s_mul_i32 s54, s54, 3072
    s_add_u32 s54, s54, 20940800
    s_cmp_lt_u32 s48, 32
    s_cselect_b32 s54, s54, 0x7f000000
    v_bfe_u32 v13, v4, 2, 2
    v_lshl_add_u32 v12, v8, 3, v13
    v_mul_u32_u24 v47, 384, v12
    s_mul_i32 s24, s22, 48
    s_add_u32 s24, s24, 102656
    v_add_u32 v47, s24, v47
    v_and_b32 v12, 1, v4
    v_lshl_add_u32 v48, v12, 3, v47
    v_bfe_u32 v12, v4, 1, 1
    v_mul_u32_u24 v12, 12288, v12
    v_add_u32 v48, v48, v12
    v_and_b32 v12, 3, v4
    v_lshl_add_u32 v47, v12, 3, v47
    s_waitcnt lgkmcnt(0)
    s_mov_b32 s36, s62
    s_mov_b32 s37, s63
    s_mov_b32 s38, 1966080
    s_mov_b32 s39, 0x00020000
    s_add_u32 s44, s4, 17039360
    s_addc_u32 s45, s5, 0
    s_mov_b32 s46, 1966080
    s_mov_b32 s47, 0x00020000
    s_and_b32 s49, s48, 1
    s_lshr_b32 s50, s48, 1
    s_lshl_b32 s51, s50, 2
    s_add_u32 s51, s51, s22
    s_mul_i32 s51, s51, 10240
    s_mul_i32 s24, s49, 640
    s_add_u32 s51, s51, s24
    s_mov_b32 m0, s90
    s_nop 0
    buffer_load_dwordx4 v16, s[36:39], s51 offen offset:0 nt lds
    buffer_load_dwordx4 v17, s[36:39], s51 offen offset:1024 nt lds
    buffer_load_dwordx4 v18, s[36:39], s51 offen offset:2048 nt lds
    buffer_load_dwordx4 v19, s[36:39], s51 offen offset:3072 nt lds
    s_add_u32 m0, s90, 4096
    s_add_u32 s51, s51, 4096
    buffer_load_dwordx4 v20, s[36:39], s51 offen nt lds
    s_lshl_b32 s52, s49, 2
    s_add_u32 s52, s52, s22
    s_mul_i32 s52, s52, 48
    s_add_u32 s52, s52, s50
    s_mul_i32 s52, s52, 5120
    s_add_u32 s53, s52, 4096
    s_lshl_b32 s98, s22, 8
    s_add_u32 s98, s98, s2
    s_cmp_lg_u32 s98, 255
    s_cbranch_scc1 LAG1_x
    s_mov_b32 s101, 50176
    s_waitcnt vmcnt(15)
    buffer_load_dwordx4 v[252:255], v5, s[12:15], s101 offen sc1
    s_waitcnt vmcnt(0)
    v_xor_b32 v252, s100, v252
    v_xor_b32 v253, s100, v253
    v_xor_b32 v254, s100, v254
    v_xor_b32 v255, s100, v255
    v_or3_b32 v252, v252, v253, v254
    v_or_b32 v252, v252, v255
    v_cmp_ne_u32 s[98:99], 0, v252
    s_nop 0
    s_cmp_lg_u64 s[98:99], 0
    s_nop 1
    s_cbranch_scc1 LAG1_slow
LAG1_ok:
    s_mov_b64 exec, -1
    v_mov_b32 v250, s100
    v_lshlrev_b32 v251, 7, v4
    s_mov_b32 s98, 52224
    s_mov_b64 exec, 0xff
    buffer_store_dword v250, v251, s[12:15], s98 offen sc1
    s_mov_b32 s98, 32768
    s_mov_b64 exec, 1
    buffer_store_dword v250, v251, s[12:15], s98 offen sc1
    s_mov_b64 exec, -1
LAG1_x:
    s_waitcnt vmcnt(0)
    s_barrier
    ds_read_b64_tr_b16 v[24:25], v14 offset:0
    ds_read_b64_tr_b16 v[26:27], v14 offset:2560
    ds_read_b64_tr_b16 v[28:29], v14 offset:8
    ds_read_b64_tr_b16 v[30:31], v14 offset:2568
    ds_read_b64_tr_b16 v[32:33], v14 offset:16
    ds_read_b64_tr_b16 v[34:35], v14 offset:2576
    ds_read_b64_tr_b16 v[36:37], v14 offset:24
    ds_read_b64_tr_b16 v[38:39], v14 offset:2584
    ds_read_b64_tr_b16 v[40:41], v14 offset:32
    ds_read_b64_tr_b16 v[42:43], v14 offset:2592
    s_waitcnt lgkmcnt(8)
    buffer_store_dwordx4 v[24:27], v5, s[44:47], s52 offen offset:0 sc1
    s_waitcnt lgkmcnt(6)
    buffer_store_dwordx4 v[28:31], v5, s[44:47], s52 offen offset:1024 sc1
    s_waitcnt lgkmcnt(4)
    buffer_store_dwordx4 v[32:35], v5, s[44:47], s52 offen offset:2048 sc1
    s_waitcnt lgkmcnt(2)
    buffer_store_dwordx4 v[36:39], v5, s[44:47], s52 offen offset:3072 sc1
    s_waitcnt lgkmcnt(0)
    buffer_store_dwordx4 v[40:43], v5, s[44:47], s53 offen offset:0 sc1
    ds_read_b64_tr_b16 v[52:53], v47 offset:0
    ds_read_b64_tr_b16 v[54:55], v47 offset:1536
    ds_read_b64_tr_b16 v[56:57], v47 offset:12288
    ds_read_b64_tr_b16 v[58:59], v47 offset:13824
    ds_read_b64_tr_b16 v[60:61], v48 offset:32
    ds_read_b64_tr_b16 v[62:63], v48 offset:1568
    ds_read_b64_tr_b16 v[64:65], v47 offset:192
    ds_read_b64_tr_b16 v[66:67], v47 offset:1728
    ds_read_b64_tr_b16 v[68:69], v47 offset:12480
    ds_read_b64_tr_b16 v[70:71], v47 offset:14016
    ds_read_b64_tr_b16 v[72:73], v48 offset:224
    ds_read_b64_tr_b16 v[74:75], v48 offset:1760
    s_add_u32 s34, s54, 0
    s_waitcnt lgkmcnt(10)
    buffer_store_dwordx4 v[52:55], v5, s[12:15], s34 offen offset:0 sc1
    s_waitcnt lgkmcnt(8)
    buffer_store_dwordx4 v[56:59], v5, s[12:15], s34 offen offset:1024 sc1
    s_waitcnt lgkmcnt(6)
    buffer_store_dwordx4 v[60:63], v5, s[12:15], s34 offen offset:2048 sc1
    s_add_u32 s34, s54, 122880
    s_waitcnt lgkmcnt(4)
    buffer_store_dwordx4 v[64:67], v5, s[12:15], s34 offen offset:0 sc1
    s_waitcnt lgkmcnt(2)
    buffer_store_dwordx4 v[68:71], v5, s[12:15], s34 offen offset:1024 sc1
    s_waitcnt lgkmcnt(0)
    buffer_store_dwordx4 v[72:75], v5, s[12:15], s34 offen offset:2048 sc1
    s_cmp_lg_u32 s2, 250
    s_cbranch_scc1 LWD1
    s_movk_i32 s48, 95
    s_waitcnt lgkmcnt(0)
    s_barrier
    s_and_b32 s49, s48, 1
    s_lshr_b32 s50, s48, 1
    s_lshl_b32 s51, s50, 2
    s_add_u32 s51, s51, s22
    s_mul_i32 s51, s51, 10240
    s_mul_i32 s24, s49, 640
    s_add_u32 s51, s51, s24
    s_mov_b32 m0, s90
    s_nop 0
    buffer_load_dwordx4 v16, s[36:39], s51 offen offset:0 nt lds
    buffer_load_dwordx4 v17, s[36:39], s51 offen offset:1024 nt lds
    buffer_load_dwordx4 v18, s[36:39], s51 offen offset:2048 nt lds
    buffer_load_dwordx4 v19, s[36:39], s51 offen offset:3072 nt lds
    s_add_u32 m0, s90, 4096
    s_add_u32 s51, s51, 4096
    buffer_load_dwordx4 v20, s[36:39], s51 offen nt lds
    s_lshl_b32 s52, s49, 2
    s_add_u32 s52, s52, s22
    s_mul_i32 s52, s52, 48
    s_add_u32 s52, s52, s50
    s_mul_i32 s52, s52, 5120
    s_add_u32 s53, s52, 4096
    s_waitcnt vmcnt(0)
    s_barrier
    ds_read_b64_tr_b16 v[24:25], v14 offset:0
    ds_read_b64_tr_b16 v[26:27], v14 offset:2560
    ds_read_b64_tr_b16 v[28:29], v14 offset:8
    ds_read_b64_tr_b16 v[30:31], v14 offset:2568
    ds_read_b64_tr_b16 v[32:33], v14 offset:16
    ds_read_b64_tr_b16 v[34:35], v14 offset:2576
    ds_read_b64_tr_b16 v[36:37], v14 offset:24
    ds_read_b64_tr_b16 v[38:39], v14 offset:2584
    ds_read_b64_tr_b16 v[40:41], v14 offset:32
    ds_read_b64_tr_b16 v[42:43], v14 offset:2592
    s_waitcnt lgkmcnt(8)
    buffer_store_dwordx4 v[24:27], v5, s[44:47], s52 offen offset:0 sc1
    s_waitcnt lgkmcnt(6)
    buffer_store_dwordx4 v[28:31], v5, s[44:47], s52 offen offset:1024 sc1
    s_waitcnt lgkmcnt(4)
    buffer_store_dwordx4 v[32:35], v5, s[44:47], s52 offen offset:2048 sc1
    s_waitcnt lgkmcnt(2)
    buffer_store_dwordx4 v[36:39], v5, s[44:47], s52 offen offset:3072 sc1
    s_waitcnt lgkmcnt(0)
    buffer_store_dwordx4 v[40:43], v5, s[44:47], s53 offen offset:0 sc1
    s_nop 0
LWD1:
    v_mov_b32 v251, 0
    s_and_b32 s101, s2, 7
    s_lshl_b32 s101, s101, 7
    s_add_u32 s101, s101, 52224
    buffer_load_dword v249, v251, s[12:15], s101 offen sc1
    s_waitcnt vmcnt(0)
    v_readfirstlane_b32 s98, v249
    s_nop 0
    s_cmp_lg_u32 s98, s100
    s_nop 1
    s_cbranch_scc1 LG1w_slow
LG1w_ok:
    s_sub_u32 s48, s2, 244
    s_cmp_ge_u32 s48, 3
    s_cbranch_scc1 LWD0
    s_lshl_b32 s48, s48, 8
    v_add_u32 v120, s48, v0
    v_lshlrev_b32 v121, 4, v120
    s_add_u32 s8, s4, 22937600
    s_addc_u32 s9, s5, 0
    s_mov_b32 s10, 61440
    s_mov_b32 s11, 0x00020000
    s_mov_b32 s49, 5120
    buffer_load_dwordx4 v[124:127], v121, s[8:11], s49 offen sc1
    s_mov_b32 s49, 20480
    buffer_load_dwordx4 v[128:131], v121, s[8:11], s49 offen sc1
    s_mov_b32 s49, 35840
    buffer_load_dwordx4 v[132:135], v121, s[8:11], s49 offen sc1
    s_mov_b32 s49, 51200
    buffer_load_dwordx4 v[136:139], v121, s[8:11], s49 offen sc1
    s_add_u32 s12, s4, 5120
    s_addc_u32 s13, s5, 0
    s_mov_b32 s14, 10240
    s_mov_b32 s15, 0x00020000
    s_mov_b32 s50, 0x04000c0c
    s_mov_b32 s51, 0x0706000c
    v_mov_b32 v142, 0x34cccccd
    v_cmp_gt_u32 vcc, 0xa0, v120
    s_nop 1
    v_cndmask_b32 v142, 1.0, v142, vcc
    v_subrev_u32 v141, 0x140, v120
    v_cmp_gt_u32 vcc, 0xa0, v141
    v_mov_b32 v143, 1.0
    s_nop 0
    v_cndmask_b32 v143, 0, v143, vcc
    s_waitcnt vmcnt(3)
    v_perm_b32 v141, v124, v125, s50
    v_perm_b32 v127, v141, v126, s51
    s_waitcnt vmcnt(2)
    v_perm_b32 v141, v128, v129, s50
    v_perm_b32 v131, v141, v130, s51
    s_waitcnt vmcnt(1)
    v_perm_b32 v141, v132, v133, s50
    v_perm_b32 v135, v141, v134, s51
    s_waitcnt vmcnt(0)
    v_perm_b32 v141, v136, v137, s50
    v_perm_b32 v139, v141, v138, s51
    v_pk_add_f32 v[124:125], v[124:125], v[128:129]
    v_pk_add_f32 v[132:133], v[132:133], v[136:137]
    v_pk_add_f32 v[126:127], v[126:127], v[130:131]
    v_pk_add_f32 v[134:135], v[134:135], v[138:139]
    v_pk_add_f32 v[124:125], v[124:125], v[132:133]
    v_pk_add_f32 v[126:127], v[126:127], v[134:135]
    v_cvt_pk_bf16_f32 v124, v124, v124
    v_cvt_pk_bf16_f32 v125, v125, v125
    v_cvt_pk_bf16_f32 v126, v126, v126
    v_cvt_pk_bf16_f32 v127, v127, v127
    v_and_b32 v124, 0xffff0000, v124
    v_and_b32 v125, 0xffff0000, v125
    v_and_b32 v126, 0xffff0000, v126
    v_and_b32 v127, 0xffff0000, v127
    v_add_f32 v124, v143, v124
    v_add_f32 v125, v143, v125
    v_add_f32 v126, v143, v126
    v_add_f32 v127, v143, v127
    v_cvt_pk_bf16_f32 v124, v124, v124
    v_cvt_pk_bf16_f32 v125, v125, v125
    v_cvt_pk_bf16_f32 v126, v126, v126
    v_cvt_pk_bf16_f32 v127, v127, v127
    v_and_b32 v124, 0xffff0000, v124
    v_and_b32 v125, 0xffff0000, v125
    v_and_b32 v126, 0xffff0000, v126
    v_and_b32 v127, 0xffff0000, v127
    v_mul_f32 v124, v142, v124
    v_mul_f32 v125, v142, v125
    v_mul_f32 v126, v142, v126
    v_mul_f32 v127, v142, v127
    buffer_store_dwordx4 v[124:127], v121, s[12:15], 0 offen sc1
    s_nop 0
LWD0:
    s_sub_u32 s48, s2, 161
    s_and_b32 s20, s2, 6
    s_lshl_b32 s20, s20, 1
    s_lshr_b32 s21, s2, 6
    s_add_u32 s20, s20, s21
    s_bfe_u32 s56, s2, 0x30003
    s_and_b32 s57, s2, 1
    s_lshl_b32 s21, s57, 3
    s_add_u32 s21, s21, s56
    s_lshl_b32 s25, s20, 4
    s_add_u32 s3, s25, s21
    s_lshr_b32 s25, s20, 2
    s_lshl_b32 s25, s25, 12
    s_lshl_b32 s24, s57, 11
    s_add_u32 s25, s25, s24
    s_and_b32 s24, s21, 1
    s_lshl_b32 s24, s24, 10
    s_add_u32 s25, s25, s24
    s_and_b32 s24, s20, 3
    s_lshl_b32 s24, s24, 8
    s_add_u32 s25, s25, s24
    s_and_b32 s24, s21, 6
    s_lshl_b32 s24, s24, 5
    s_add_u32 s25, s25, s24
    s_add_u32 s26, s25, 1048576
    s_add_u32 s27, s25, 2097152
    s_mul_i32 s30, s22, 2560
    s_add_u32 s30, s30, 32768
    s_lshl_b32 s31, s22, 11
    s_add_u32 s88, s31, 43008
    s_add_u32 s31, s31, 5120
    s_lshl_b32 s32, s21, 2
    s_add_u32 s32, s32, s22
    s_mul_i32 s24, s32, 30720
    s_add_u32 s24, s24, 19005440
    v_add_u32 v6, s24, v5
    s_mul_i32 s58, s20, 393216
    s_mul_i32 s24, s32, 768
    s_add_u32 s58, s58, s24
    s_add_u32 s58, s58, 10747904
    s_add_u32 s59, s58, 98304
    s_add_u32 s60, s58, 196608
    s_add_u32 s61, s58, 294912
    s_and_b32 s89, s2, 7
    s_lshl_b32 s89, s89, 7
    s_add_u32 s89, s89, 45056
    s_mov_b32 s12, s4
    s_mov_b32 s13, s5
    s_mov_b32 s14, 25714688
    s_mov_b32 s15, 0x00020000
    s_add_u32 s16, s4, 65536
    s_addc_u32 s17, s5, 0
    s_mov_b32 s18, 2637824
    s_mov_b32 s19, 0x00020000
    v_mov_b32 v2, 0
    v_mov_b32 v3, 1
    buffer_load_dwordx4 a[0:3], v6, s[12:15], 0 offen offset:0 sc1
    buffer_load_dwordx4 a[4:7], v6, s[12:15], 0 offen offset:1024 sc1
    buffer_load_dwordx4 a[8:11], v6, s[12:15], 0 offen offset:2048 sc1
    buffer_load_dwordx4 a[12:15], v6, s[12:15], 0 offen offset:3072 sc1
    v_add_u32 v6, 0x1000, v6
    s_waitcnt vmcnt(4)
    s_barrier
    s_cmp_lg_u32 s22, 0
    s_cbranch_scc1 LFW_s
    v_mov_b32 v12, 1
    v_lshlrev_b32 v13, 7, v4
    s_mov_b32 s35, 47104
    s_mov_b64 exec, 1
    buffer_atomic_add v12, v2, s[12:15], s35 offen sc0 sc1
    s_waitcnt vmcnt(0)
    v_readfirstlane_b32 s35, v12
    s_nop 0
    s_cmp_eq_u32 s35, 94
    s_cselect_b64 exec, 0xff, 0
    s_mov_b32 s35, 46080
    s_nop 0
    buffer_store_dword v3, v13, s[12:15], s35 offen sc1
    s_mov_b64 exec, -1
LFW_s:
    buffer_load_dwordx4 a[16:19], v6, s[12:15], 0 offen offset:0 sc1
    buffer_load_dwordx4 a[20:23], v6, s[12:15], 0 offen offset:1024 sc1
    buffer_load_dwordx4 a[24:27], v6, s[12:15], 0 offen offset:2048 sc1
    buffer_load_dwordx4 a[28:31], v6, s[12:15], 0 offen offset:3072 sc1
    v_add_u32 v6, 0x1000, v6
    buffer_load_dwordx4 a[32:35], v6, s[12:15], 0 offen offset:0 sc1
    buffer_load_dwordx4 a[36:39], v6, s[12:15], 0 offen offset:1024 sc1
    buffer_load_dwordx4 a[40:43], v6, s[12:15], 0 offen offset:2048 sc1
    buffer_load_dwordx4 a[44:47], v6, s[12:15], 0 offen offset:3072 sc1
    v_add_u32 v6, 0x1000, v6
    buffer_load_dwordx4 a[48:51], v6, s[12:15], 0 offen offset:0 sc1
    buffer_load_dwordx4 a[52:55], v6, s[12:15], 0 offen offset:1024 sc1
    buffer_load_dwordx4 a[56:59], v6, s[12:15], 0 offen offset:2048 sc1
    buffer_load_dwordx4 a[60:63], v6, s[12:15], 0 offen offset:3072 sc1
    v_add_u32 v6, 0x1000, v6
    buffer_load_dwordx4 a[64:67], v6, s[12:15], 0 offen offset:0 sc1
    buffer_load_dwordx4 a[68:71], v6, s[12:15], 0 offen offset:1024 sc1
    buffer_load_dwordx4 a[72:75], v6, s[12:15], 0 offen offset:2048 sc1
    buffer_load_dwordx4 a[76:79], v6, s[12:15], 0 offen offset:3072 sc1
    v_add_u32 v6, 0x1000, v6
    buffer_load_dwordx4 a[80:83], v6, s[12:15], 0 offen offset:0 sc1
    buffer_load_dwordx4 a[84:87], v6, s[12:15], 0 offen offset:1024 sc1
    buffer_load_dwordx4 a[88:91], v6, s[12:15], 0 offen offset:2048 sc1
    buffer_load_dwordx4 a[92:95], v6, s[12:15], 0 offen offset:3072 sc1
    v_add_u32 v6, 0x1000, v6
    v_lshrrev_b32 v12, 2, v0
    v_lshlrev_b32 v12, 14, v12
    v_and_b32 v85, 3, v0
    v_lshl_add_u32 v12, v85, 4, v12
    v_lshrrev_b32 v85, 1, v0
    v_cmp_ge_u32 s[34:35], 64, v85
    v_mov_b32 v32, -1
    v_add_u32 v93, s88, v5
    v_mov_b32 v2, 0
    v_mov_b32 v3, 1
    v_lshrrev_b32 v90, 1, v8
    v_mad_u32_u24 v89, v7, 5, v90
    v_and_b32 v88, 1, v8
    v_mul_u32_u24 v9, 49152, v88
    v_lshlrev_b32 v10, 2, v9
    v_lshl_add_u32 v9, v90, 8, v9
    buffer_load_dwordx4 a[96:99], v6, s[12:15], 0 offen offset:0 sc1
    v_lshl_add_u32 v9, v7, 4, v9
    v_mul_u32_u24 v90, 49152, v90
    v_add_u32 v10, v10, v90
    v_lshl_add_u32 v10, v7, 4, v10
    v_lshl_add_u32 v88, v1, 1, v88
    v_add_u32 v90, 0, v89
    buffer_load_dwordx4 a[100:103], v6, s[12:15], 0 offen offset:1024 sc1
    v_xor_b32 v18, v90, v88
    v_and_b32 v18, 7, v18
    v_lshl_add_u32 v18, v90, 3, v18
    v_lshlrev_b32 v18, 4, v18
    v_add_u32 v18, 122880, v18
    v_add_u32 v90, 2, v89
    buffer_load_dwordx4 a[104:107], v6, s[12:15], 0 offen offset:2048 sc1
    v_xor_b32 v19, v90, v88
    v_and_b32 v19, 7, v19
    v_lshl_add_u32 v19, v90, 3, v19
    v_lshlrev_b32 v19, 4, v19
    v_add_u32 v19, 122880, v19
    v_add_u32 v90, 4, v89
    buffer_load_dwordx4 a[108:111], v6, s[12:15], 0 offen offset:3072 sc1
    v_add_u32 v6, 0x1000, v6
    v_xor_b32 v20, v90, v88
    v_and_b32 v20, 7, v20
    v_lshl_add_u32 v20, v90, 3, v20
    v_lshlrev_b32 v20, 4, v20
    v_add_u32 v20, 122880, v20
    v_mul_u32_u24 v21, 1280, v88
    buffer_load_dwordx4 a[112:115], v6, s[12:15], 0 offen offset:0 sc1
    v_lshl_add_u32 v21, v89, 4, v21
    v_add_u32 v21, 122880, v21
    v_lshrrev_b32 v90, 3, v0
    v_xor_b32 v22, v90, v0
    v_and_b32 v22, 7, v22
    v_lshlrev_b32 v22, 4, v22
    buffer_load_dwordx4 a[116:119], v6, s[12:15], 0 offen offset:1024 sc1
    v_add_u32 v6, 1937408, v6
    v_lshl_add_u32 v22, v90, 8, v22
    v_and_b32 v84, 1, v0
    v_mul_u32_u24 v13, 5184, v84
    v_sub_u32 v14, 384, v85
    v_lshl_add_u32 v14, v14, 2, v13
    v_lshl_add_u32 v13, v85, 2, v13
    buffer_load_dwordx4 a[120:123], v6, s[12:15], 0 offen offset:0 sc1
    s_mul_i32 s24, s22, 2592
    v_lshl_add_u32 v15, v4, 2, s24
    v_mov_b32 v142, 0
    v_mov_b32 v143, 0
    v_mul_u32_u24 v16, 80, v7
    v_lshl_add_u32 v16, v8, 3, v16
    buffer_load_dwordx4 a[124:127], v6, s[12:15], 0 offen offset:1024 sc1
    v_lshlrev_b32 v17, 1, v16
    v_add_u32 v16, s30, v16
    v_mov_b32 v44, 0
    v_mov_b32 v45, 0
    v_mov_b32 v46, 0
    v_mov_b32 v47, 0
    s_mov_b32 m0, s88
    s_nop 0
    buffer_load_dwordx4 v5, s[12:15], s31 offen sc1 lds
    buffer_load_dwordx4 v5, s[12:15], s31 offen offset:1024 sc1 lds
    s_lshl_b32 s48, s48, 14
    s_add_u32 s48, s48, s25
    v_mov_b32 v91, 0
    s_mov_b32 s24, 0x400
    s_cmp_lg_u32 s22, 0
    s_cbranch_scc1 LCAN_o
LCAN:
    s_sleep 4
    buffer_load_dword v92, v91, s[16:19], s48 offen sc1
    s_waitcnt vmcnt(0)
    v_readfirstlane_b32 s49, v92
    s_sub_u32 s24, s24, 1
    s_nop 2
    s_cbranch_scc1 LCAN_o
    s_bitcmp0_b32 s49, 0
    s_cbranch_scc1 LCAN
LCAN_o:
    s_barrier
    s_branch LJOIN
LV0_slow:
    s_mov_b32 s32, m0
    s_mov_b32 s24, 0x40000
LV0_loop:
    s_add_u32 s50, s50, 16
    s_add_u32 m0, s52, 0
    s_nop 0
    buffer_load_dwordx4 v5, s[16:19], m0 offen offset:0 sc1 lds
    buffer_load_dwordx4 v5, s[16:19], m0 offen offset:1024 sc1 lds
    buffer_load_dwordx4 v5, s[16:19], m0 offen offset:2048 sc1 lds
    buffer_load_dwordx4 v5, s[16:19], m0 offen offset:3072 sc1 lds
    s_mov_b32 m0, s32
    s_waitcnt vmcnt(0)
    s_sub_u32 s24, s24, 1
    s_cbranch_scc1 LV0_ok
    ds_read2st64_b32 v[172:173], v187 offset0:0 offset1:4
    ds_read2st64_b32 v[174:175], v187 offset0:8 offset1:12
    s_waitcnt lgkmcnt(0)
    v_bitop3_b32 v172, v172, v173, v174 bitop3:0x80
    v_bitop3_b32 v172, v172, v175, 1 bitop3:0x80
    v_cmp_eq_u32 s[62:63], 0, v172
    s_nop 0
    s_cmp_lg_u64 s[62:63], 0
    s_nop 1
    s_cbranch_scc1 LV0_loop
    s_branch LV0_ok
LV1_slow:
    s_mov_b32 s32, m0
    s_mov_b32 s24, 0x40000
LV1_loop:
    s_add_u32 s50, s50, 256
    s_add_u32 m0, s52, 4096
    s_nop 0
    buffer_load_dwordx4 v5, s[16:19], m0 offen offset:0 sc1 lds
    buffer_load_dwordx4 v5, s[16:19], m0 offen offset:1024 sc1 lds
    buffer_load_dwordx4 v5, s[16:19], m0 offen offset:2048 sc1 lds
    buffer_load_dwordx4 v5, s[16:19], m0 offen offset:3072 sc1 lds
    s_mov_b32 m0, s32
    s_waitcnt vmcnt(0)
    s_sub_u32 s24, s24, 1
    s_cbranch_scc1 LV1_ok
    ds_read2st64_b32 v[172:173], v187 offset0:16 offset1:20
    ds_read2st64_b32 v[174:175], v187 offset0:24 offset1:28
    s_waitcnt lgkmcnt(0)
    v_bitop3_b32 v172, v172, v173, v174 bitop3:0x80
    v_bitop3_b32 v172, v172, v175, 1 bitop3:0x80
    v_cmp_eq_u32 s[62:63], 0, v172
    s_nop 0
    s_cmp_lg_u64 s[62:63], 0
    s_nop 1
    s_cbranch_scc1 LV1_loop
    s_branch LV1_ok
LV2_slow:
    s_mov_b32 s32, m0
    s_mov_b32 s24, 0x40000
LV2_loop:
    s_add_u32 s50, s50, 256
    s_add_u32 m0, s52, 8192
    s_nop 0
    buffer_load_dwordx4 v5, s[16:19], m0 offen offset:0 sc1 lds
    buffer_load_dwordx4 v5, s[16:19], m0 offen offset:1024 sc1 lds
    buffer_load_dwordx4 v5, s[16:19], m0 offen offset:2048 sc1 lds
    buffer_load_dwordx4 v5, s[16:19], m0 offen offset:3072 sc1 lds
    s_mov_b32 m0, s32
    s_waitcnt vmcnt(0)
    s_sub_u32 s24, s24, 1
    s_cbranch_scc1 LV2_ok
    ds_read2st64_b32 v[172:173], v187 offset0:32 offset1:36
    ds_read2st64_b32 v[174:175], v187 offset0:40 offset1:44
    s_waitcnt lgkmcnt(0)
    v_bitop3_b32 v172, v172, v173, v174 bitop3:0x80
    v_bitop3_b32 v172, v172, v175, 1 bitop3:0x80
    v_cmp_eq_u32 s[62:63], 0, v172
    s_nop 0
    s_cmp_lg_u64 s[62:63], 0
    s_nop 1
    s_cbranch_scc1 LV2_loop
    s_branch LV2_ok
LV3_slow:
    s_mov_b32 s32, m0
    s_mov_b32 s24, 0x40000
LV3_loop:
    s_add_u32 s50, s50, 256
    s_add_u32 m0, s52, 12288
    s_nop 0
    buffer_load_dwordx4 v5, s[16:19], m0 offen offset:0 sc1 lds
    buffer_load_dwordx4 v5, s[16:19], m0 offen offset:1024 sc1 lds
    buffer_load_dwordx4 v5, s[16:19], m0 offen offset:2048 sc1 lds
    buffer_load_dwordx4 v5, s[16:19], m0 offen offset:3072 sc1 lds
    s_add_u32 m0, s52, 16384
    s_nop 0
    buffer_load_dwordx4 v5, s[16:19], m0 offen offset:0 sc1 lds
    buffer_load_dwordx4 v5, s[16:19], m0 offen offset:1024 sc1 lds
    buffer_load_dwordx4 v5, s[16:19], m0 offen offset:2048 sc1 lds
    buffer_load_dwordx4 v5, s[16:19], m0 offen offset:3072 sc1 lds
    s_mov_b32 m0, s32
    s_waitcnt vmcnt(0)
    s_sub_u32 s24, s24, 1
    s_cbranch_scc1 LV3_ok
    ds_read2st64_b32 v[172:173], v187 offset0:48 offset1:52
    ds_read2st64_b32 v[174:175], v187 offset0:56 offset1:60
    ds_read2st64_b32 v[176:177], v187 offset0:64 offset1:68
    ds_read2st64_b32 v[178:179], v187 offset0:72 offset1:76
    s_waitcnt lgkmcnt(2)
    v_bitop3_b32 v172, v172, v173, v174 bitop3:0x80
    s_waitcnt lgkmcnt(1)
    v_bitop3_b32 v172, v172, v175, v176 bitop3:0x80
    s_waitcnt lgkmcnt(0)
    v_bitop3_b32 v172, v172, v177, v178 bitop3:0x80
    v_bitop3_b32 v172, v172, v179, 1 bitop3:0x80
    v_cmp_eq_u32 s[62:63], 0, v172
    s_nop 0
    s_cmp_lg_u64 s[62:63], 0
    s_nop 1
    s_cbranch_scc1 LV3_loop
    s_branch LV3_ok
LG1c_slow:
    s_mov_b32 s91, 0x40000
LG1c_loop:
    s_sleep 3
    v_mov_b32 v251, 0
    s_and_b32 s101, s2, 7
    s_lshl_b32 s101, s101, 7
    s_add_u32 s101, s101, 52224
    buffer_load_dword v249, v251, s[12:15], s101 offen sc1
    s_waitcnt vmcnt(0)
    s_sub_u32 s91, s91, 1
    s_cbranch_scc1 LG1c_ok
    v_readfirstlane_b32 s98, v249
    s_nop 0
    s_cmp_lg_u32 s98, s100
    s_nop 1
    s_cbranch_scc1 LG1c_loop
    s_branch LG1c_ok
LG1w_slow:
    s_mov_b32 s91, 0x40000
LG1w_loop:
    s_sleep 3
    v_mov_b32 v251, 0
    s_and_b32 s101, s2, 7
    s_lshl_b32 s101, s101, 7
    s_add_u32 s101, s101, 52224
    buffer_load_dword v249, v251, s[12:15], s101 offen sc1
    s_waitcnt vmcnt(0)
    s_sub_u32 s91, s91, 1
    s_cbranch_scc1 LG1w_ok
    v_readfirstlane_b32 s98, v249
    s_nop 0
    s_cmp_lg_u32 s98, s100
    s_nop 1
    s_cbranch_scc1 LG1w_loop
    s_branch LG1w_ok
LA0c_slow:
    s_mov_b32 s91, 0x40000
LA0c_loop:
    s_sleep 24
    s_mov_b32 s101, 49152
    buffer_load_dwordx4 v[252:255], v5, s[12:15], s101 offen sc1
    s_waitcnt vmcnt(0)
    s_sub_u32 s91, s91, 1
    s_cbranch_scc1 LA0c_ok
    v_xor_b32 v252, s100, v252
    v_xor_b32 v253, s100, v253
    v_xor_b32 v254, s100, v254
    v_xor_b32 v255, s100, v255
    v_or3_b32 v252, v252, v253, v254
    v_or_b32 v252, v252, v255
    v_cmp_ne_u32 s[98:99], 0, v252
    s_nop 0
    s_cmp_lg_u64 s[98:99], 0
    s_nop 1
    s_cbranch_scc1 LA0c_loop
    s_branch LA0c_ok
LAG1_slow:
    s_mov_b32 s91, 0x40000
LAG1_loop:
    s_sleep 6
    s_mov_b32 s101, 50176
    buffer_load_dwordx4 v[252:255], v5, s[12:15], s101 offen sc1
    s_waitcnt vmcnt(0)
    s_sub_u32 s91, s91, 1
    s_cbranch_scc1 LAG1_ok
    v_xor_b32 v252, s100, v252
    v_xor_b32 v253, s100, v253
    v_xor_b32 v254, s100, v254
    v_xor_b32 v255, s100, v255
    v_or3_b32 v252, v252, v253, v254
    v_or_b32 v252, v252, v255
    v_cmp_ne_u32 s[98:99], 0, v252
    s_nop 0
    s_cmp_lg_u64 s[98:99], 0
    s_nop 1
    s_cbranch_scc1 LAG1_loop
    s_branch LAG1_ok
LH1_spin:
    s_mov_b32 s24, 0x100000
LH1_loop:
    s_sleep 2
    buffer_load_dword v11, v2, s[12:15], s54 offen sc1
    s_waitcnt vmcnt(0)
    v_readfirstlane_b32 s33, v11
    s_sub_u32 s24, s24, 1
    s_nop 2
    s_cbranch_scc1 LH1_ok
    s_cmp_lt_u32 s33, 16
    s_cbranch_scc1 LH1_loop
    s_branch LH1_ok
LHA_spin:
    s_mov_b32 s24, 0x100000
LHA_loop:
    s_sleep 2
    buffer_load_dword v11, v2, s[12:15], s55 offen sc1
    s_waitcnt vmcnt(0)
    v_readfirstlane_b32 s33, v11
    s_sub_u32 s24, s24, 1
    s_nop 2
    s_cbranch_scc1 LHA_ok
    s_cmp_lt_u32 s33, 16
    s_cbranch_scc1 LHA_loop
    s_branch LHA_ok
LHB_spin:
    s_mov_b32 s24, 0x100000
LHB_loop:
    s_sleep 2
    buffer_load_dword v11, v2, s[12:15], s51 offen sc1
    s_waitcnt vmcnt(0)
    v_readfirstlane_b32 s33, v11
    s_sub_u32 s24, s24, 1
    s_nop 2
    s_cbranch_scc1 LHB_ok
    s_cmp_lt_u32 s33, 16
    s_cbranch_scc1 LHB_loop
    s_branch LHB_ok
Lcode_end:
.section .rodata,"a"
.p2align 6
.amdhsa_kernel kd_kernel
  .amdhsa_next_free_vgpr 512
  .amdhsa_next_free_sgpr 102
  .amdhsa_accum_offset 256
  .amdhsa_group_segment_fixed_size 0
  .amdhsa_kernarg_size 96
  .amdhsa_user_sgpr_count 2
  .amdhsa_user_sgpr_kernarg_segment_ptr 1
  .amdhsa_system_sgpr_workgroup_id_x 1
.end_amdhsa_kernel
```
